```python
import torch

def _softmax(x, axis=-1):
    return torch.softmax(x, dim=axis)
def _gelu(x):
    return torch.nn.functional.gelu(x, approximate="tanh")
def _silu(x):
    return torch.nn.functional.silu(x)
def _sigmoid(x):
    return torch.sigmoid(x)
def _layernorm(x, axis=-1, eps=1e-5):
    m = x.mean(dim=axis, keepdim=True)
    v = x.var(dim=axis, keepdim=True, unbiased=False)
    return (x - m) / torch.sqrt(v + eps)
def _scatter_add(tgt, idx, src, axis=0):
    return tgt.clone().index_add_(axis, idx, src)
def _segment_sum(src, seg, n):
    out = torch.zeros((n,) + src.shape[1:], dtype=src.dtype)
    return out.index_add_(0, seg, src)
def _pad(x, pw):
    flat = tuple(v for pair in reversed(pw) for v in pair)
    return torch.nn.functional.pad(x, flat)

kernel_name = 'recurrent_scan__sliding_local_dilated__swiglu_ffn__prompt'

def setup_inputs():

    _w = (lambda a: (lambda t: t.to(torch.bfloat16) if t.is_floating_point() else t)(torch.as_tensor(a)))
    def _A_setup():
        B, S, D = 1, 2048, 448
        return {
            "x": _w((lambda *s: torch.randn(*s, dtype=torch.bfloat16) * 0.05)(B, S, D)),
            "wqkv": _w((lambda *s: torch.randn(*s, dtype=torch.bfloat16) * 0.05)(D, 3 * D)),
            "wo": _w((lambda *s: torch.randn(*s, dtype=torch.bfloat16) * 0.05)(D, D)),
        }
    _A_in = _A_setup()

    def _B_setup():
        B, S, D, F = 1, 2048, 448, 1792
        return {
            "x": _w((lambda *s: torch.randn(*s, dtype=torch.bfloat16) * 0.05)(B, S, D)),
            "w_gate": _w((lambda *s: torch.randn(*s, dtype=torch.bfloat16) * 0.05)(D, F)),
            "w_up": _w((lambda *s: torch.randn(*s, dtype=torch.bfloat16) * 0.05)(D, F)),
            "w_down": _w((lambda *s: torch.randn(*s, dtype=torch.bfloat16) * 0.05)(F, D)),
        }
    _B_in = _B_setup()

    return {
        "A_x": _A_in["x"],
        "A_wqkv": _A_in["wqkv"],
        "A_wo": _A_in["wo"],
        "B_x": _B_in["x"],
        "B_w_gate": _B_in["w_gate"],
        "B_w_up": _B_in["w_up"],
        "B_w_down": _B_in["w_down"],
    }

def reference(A_x, A_wqkv, A_wo, B_x, B_w_gate, B_w_up, B_w_down):
    def _A_ref(x, wqkv, wo):
        B, S, D = x.shape
        H = 16; Dh = D // H
        W, dil = 8, 2
        qkv = (lambda x, *d: x.permute(*d))((x @ wqkv).reshape(B, S, 3, H, Dh), 2, 0, 3, 1, 4)
        q, k, v = qkv[0], qkv[1], qkv[2]
        scale = Dh ** -0.5
        pos = torch.arange(S)
        off = torch.arange(W) * dil
        idx = pos[:, None] - off[None, :]
        mask = idx >= 0
        idx_c = torch.where(mask, idx, 0).reshape(-1)
        kg = k[:, :, idx_c, :].reshape(B, H, S, W, Dh)
        vg = v[:, :, idx_c, :].reshape(B, H, S, W, Dh)
        logits = torch.einsum("bhsd,bhswd->bhsw", q, kg) * scale
        logits = torch.where(mask[None, None, :, :], logits, -1e9)
        attn = _softmax(logits, axis=-1)
        o = torch.einsum("bhsw,bhswd->bhsd", attn, vg)
        return (lambda x, *d: x.permute(*d))(o, 0, 2, 1, 3).reshape(B, S, D) @ wo

    def _B_ref(x, w_gate, w_up, w_down):
        g = _silu(x @ w_gate)
        u = x @ w_up
        return (g * u) @ w_down

    x = A_x
    xn = _layernorm(x, axis=-1)
    s = _A_ref(xn, A_wqkv, A_wo)
    g = _silu(_B_ref(xn, B_w_gate, B_w_up, B_w_down))
    return x + s * g
```

```asm
; @launch grid=(256,1,1) block=(512,1,1) lds=163840
.amdgcn_target "amdgcn-amd-amdhsa--gfx950"
.text
.globl recurrent_scan__sliding_local_dilated__swiglu_ffn__prompt_kernel
.p2align 8
.type recurrent_scan__sliding_local_dilated__swiglu_ffn__prompt_kernel,@function
recurrent_scan__sliding_local_dilated__swiglu_ffn__prompt_kernel:
    s_cmp_ge_u32 s2, 256
    s_cbranch_scc1 L_end
    s_load_dwordx16 s[4:19], s[0:1], 0
    s_load_dwordx4 s[20:23], s[0:1], 64
    v_and_b32 v1, 63, v0
    v_lshrrev_b32 v0, 6, v0
    v_mov_b32 v23, 0
    s_and_b32 s81, s2, 7
    s_lshr_b32 s82, s2, 3
    v_readfirstlane_b32 s64, v0
    s_mul_i32 s83, s81, 28
    s_add_u32 s83, s83, s82
    s_sub_u32 s84, s83, 112
    s_cmp_ge_u32 s83, 112
    s_cselect_b32 s83, s84, s83
    s_cselect_b32 s65, 8, 0
    s_lshr_b32 s66, s83, 3
    s_and_b32 s83, s83, 7
    s_add_u32 s65, s65, s83
    s_and_b32 s78, s82, 3
    s_lshr_b32 s83, s78, 1
    s_lshl1_add_u32 s83, s81, s83
    s_and_b32 s84, s82, 1
    s_add_u32 s84, s84, 14
    s_lshl2_add_u32 s78, s81, s78
    s_lshr_b32 s79, s82, 2
    s_cmp_ge_u32 s82, 28
    s_cselect_b32 s85, 1, 0
    s_cselect_b32 s65, s83, s65
    s_cselect_b32 s66, s84, s66
    s_lshl_b32 s67, s64, 10
    s_lshl_b32 s68, s64, 11
    s_mul_i32 s77, s64, 3072
    s_lshr_b32 s87, s64, 2
    s_and_b32 s88, s64, 3
    s_lshl2_add_u32 s95, s65, s88
    s_lshl_b32 s70, s66, 7
    s_add_u32 s75, s70, 1792
    s_cmp_eq_u32 s66, 15
    s_cselect_b32 s72, 2304, s70
    v_lshrrev_b32 v240, 3, v1
    v_and_b32 v241, 7, v1
    v_lshrrev_b32 v242, 4, v1
    v_xor_b32 v243, v241, v242
    v_lshlrev_b32 v243, 4, v243
    v_mul_u32_u24 v2, 896, v240
    v_add_u32 v2, v2, v243
    v_xor_b32 v3, 64, v2
    v_add_u32 v3, 6144, v3
    v_and_b32 v243, 1, v242
    v_lshlrev_b32 v243, 2, v243
    v_xor_b32 v243, v241, v243
    v_lshlrev_b32 v243, 4, v243
    v_mul_u32_u24 v4, 3584, v240
    v_add_u32 v4, v4, v243
    v_xor_b32 v5, 32, v4
    v_mul_u32_u24 v6, 2688, v240
    v_add_u32 v6, v6, v243
    v_mul_u32_u24 v7, 896, v240
    v_add_u32 v7, v7, v243
    v_lshlrev_b32 v15, 4, v1
    s_mul_i32 s82, s64, 28672
    s_add_u32 s70, s70, s82
    s_add_u32 s75, s75, s82
    s_mul_i32 s82, s64, 21504
    s_add_u32 s72, s72, s82
    s_add_u32 s72, s72, 1024
    s_lshl_b32 s81, s65, 7
    s_lshl_b32 s82, s64, 4
    s_add_u32 s82, s82, s81
    s_mul_i32 s69, s82, 896
    s_waitcnt lgkmcnt(0)
    s_lshr_b32 s1, s2, 3
    s_and_b32 s0, s1, 3
    s_lshl1_add_u32 s0, s0, s79
    s_sub_u32 s99, s0, 7
    s_cmp_ge_u32 s0, 7
    s_cselect_b32 s0, s99, s0
    s_lshl_b32 s0, s0, 1
    s_mov_b32 s0, 0
    s_mov_b32 s24, s4
    s_mov_b32 s25, s5
    s_mov_b32 s26, 0x1c0000
    s_mov_b32 s27, 0x20000
    s_sub_u32 s36, s6, 3072
    s_subb_u32 s37, s7, 0
    s_mov_b32 s38, 0x126c00
    s_mov_b32 s39, 0x20000
    s_mov_b32 s28, s12
    s_mov_b32 s29, s13
    s_mov_b32 s30, 0x188000
    s_mov_b32 s31, 0x20000
    s_sub_u32 s32, s14, 1024
    s_subb_u32 s33, s15, 0
    s_mov_b32 s34, 0x188400
    s_mov_b32 s35, 0x20000
    s_mov_b32 s52, s22
    s_mov_b32 s53, s23
    s_mov_b32 s54, 0xe80000
    s_mov_b32 s55, 0x20000
    s_lshl_b32 s81, s2, 3
    s_add_u32 s81, s81, s64
    s_cmp_lg_u32 s81, 7
    s_cbranch_scc1 L_nolead_1
    v_lshlrev_b32 v248, 8, v1
    v_mov_b32 v249, 0
    buffer_store_dword v249, v248, s[52:55], 0 offen sc1
    v_add_u32 v250, 16384, v248
    v_min_u32 v250, 24320, v250
    buffer_store_dword v249, v250, s[52:55], 0 offen sc1
L_nolead_1:
    s_cmp_eq_u32 s85, 1
    s_cbranch_scc1 L_light
    s_add_u32 m0, s68, 0x0
    s_nop 0
    buffer_load_dwordx4 v2, s[24:27], s69 offen lds
    buffer_load_dwordx4 v3, s[24:27], s69 offen offset:1024 lds
    s_add_u32 m0, s77, 0x4000
    s_nop 0
    buffer_load_dwordx4 v4, s[28:31], s70 offen lds
    buffer_load_dwordx4 v5, s[32:35], s70 offen offset:1024 lds
    buffer_load_dwordx4 v6, s[36:39], s72 offen offset:2048 lds
    s_barrier
    s_add_u32 m0, s68, 0xa000
    s_add_u32 s69, s69, 128
    buffer_load_dwordx4 v2, s[24:27], s69 offen lds
    buffer_load_dwordx4 v3, s[24:27], s69 offen offset:1024 lds
    s_add_u32 m0, s77, 0xe000
    s_add_u32 s70, s70, 0x38000
    buffer_load_dwordx4 v4, s[28:31], s70 offen lds
    buffer_load_dwordx4 v5, s[32:35], s70 offen offset:1024 lds
    s_add_u32 s72, s72, 0x2a000
    buffer_load_dwordx4 v6, s[36:39], s72 offen offset:2048 lds
    s_cmp_lg_u32 s64, 2
    s_cbranch_scc1 L_cpf_2
    s_getpc_b64 s[96:97]
L_here_3:
    v_lshlrev_b32 v240, 7, v1
    v_min_u32 v240, L_code_end-L_here_3, v240
    global_load_dword v0, v240, s[96:97]
    v_add_u32 v240, 8192, v240
    v_min_u32 v240, L_code_end-L_here_3, v240
    global_load_dword v0, v240, s[96:97]
    v_add_u32 v240, 8192, v240
    v_min_u32 v240, L_code_end-L_here_3, v240
    global_load_dword v0, v240, s[96:97]
    v_add_u32 v240, 8192, v240
L_cpf_2:
    s_mov_b32 s56, s20
    s_mov_b32 s57, s21
    s_mov_b32 s58, 0x100
    s_mov_b32 s59, 0x20000
    s_mov_b32 s40, s16
    s_mov_b32 s41, s17
    s_mov_b32 s42, 0x188000
    s_mov_b32 s43, 0x20000
    s_mov_b32 s44, s8
    s_mov_b32 s45, s9
    s_mov_b32 s46, 0x62000
    s_mov_b32 s47, 0x20000
    s_mov_b32 s48, s18
    s_mov_b32 s49, s19
    s_mov_b32 s50, 0x1c0000
    s_mov_b32 s51, 0x20000
    s_lshr_b32 s81, s64, 1
    s_mul_i32 s93, s81, 200704
    s_and_b32 s81, s64, 1
    s_mul_i32 s81, s81, 7168
    s_add_u32 s93, s93, s81
    s_lshl_b32 s81, s79, 7
    s_add_u32 s93, s93, s81
    s_mul_i32 s89, s95, 112
    s_lshl2_add_u32 s89, s66, s89
    s_lshl1_add_u32 s89, s87, s89
    s_lshl_b32 s89, s89, 10
    s_add_u32 s89, s89, 0x5c0000
    s_mul_i32 s81, s95, 84
    s_lshl1_add_u32 s81, s87, s81
    s_cmp_eq_u32 s66, 15
    s_cselect_b32 s82, 18, s66
    s_lshl2_add_u32 s92, s82, s81
    s_lshl_b32 s92, s92, 10
    s_add_u32 s92, s92, 0x80000
    s_and_b32 s90, s66, 3
    s_lshl2_add_u32 s90, s65, s90
    v_and_b32 v240, 31, v1
    v_lshrrev_b32 v241, 5, v1
    v_bfe_u32 v242, v1, 1, 3
    v_xor_b32 v242, v242, v241
    v_lshlrev_b32 v242, 4, v242
    v_lshl_or_b32 v8, v240, 7, v242
    s_lshl_b32 s81, s88, 12
    v_add_u32 v8, s81, v8
    v_xor_b32 v9, 32, v8
    v_xor_b32 v10, 64, v8
    v_xor_b32 v11, 96, v8
    v_bfe_u32 v240, v1, 4, 1
    v_bfe_u32 v242, v1, 2, 2
    v_lshlrev_b32 v242, 7, v242
    v_and_b32 v243, 3, v1
    v_lshl_or_b32 v242, v243, 3, v242
    v_bfe_u32 v246, v1, 3, 1
    v_lshlrev_b32 v246, 1, v246
    v_xor_b32 v246, v246, v240
    s_lshl_b32 s81, s87, 1
    v_xor_b32 v246, s81, v246
    v_lshl_or_b32 v242, v246, 5, v242
    v_mul_u32_u24 v246, 3072, v241
    v_add_u32 v14, v242, v246
    v_lshl_add_u32 v12, v240, 10, v14
    v_xor_b32 v13, 32, v12
    v_and_b32 v243, 15, v1
    v_cmp_eq_u32 vcc, v243, v240
    v_mov_b32 v243, 0x3f803f80
    v_mov_b32 v112, 0
    v_mov_b32 v113, 0
    v_mov_b32 v114, 0
    v_mov_b32 v115, 0
    v_add_u32 v116, s68, v15
    s_mov_b32 s11, 0x3f803f80
    v_cndmask_b32 v96, 0, v243, vcc
    v_cndmask_b32 v97, 0, v243, vcc
    v_cndmask_b32 v98, 0, v243, vcc
    v_cndmask_b32 v99, 0, v243, vcc
    s_mul_i32 s81, s87, 2560
    s_add_u32 s81, s81, 0x26400
    v_and_b32 v16, 31, v1
    v_lshl_add_u32 v16, v16, 4, s81
    s_waitcnt vmcnt(5)
    s_barrier
    ds_read_b128 v[128:131], v8
    ds_read_b64_tr_b16 v[24:25], v12 offset:16384
    ds_read_b64_tr_b16 v[26:27], v12 offset:16896
    ds_read_b64_tr_b16 v[28:29], v13 offset:16384
    ds_read_b64_tr_b16 v[30:31], v13 offset:16896
    ds_read_b64_tr_b16 v[32:33], v14 offset:18432
    ds_read_b64_tr_b16 v[34:35], v14 offset:18944
    s_waitcnt lgkmcnt(4)
    v_mfma_f32_32x32x16_bf16 v[48:63], v[24:27], v[128:131], 0
    ds_read_b128 v[132:135], v9
    ds_read_b64_tr_b16 v[36:37], v12 offset:22528
    ds_read_b64_tr_b16 v[38:39], v12 offset:23040
    s_add_u32 m0, s68, 0x14000
    s_add_u32 s69, s69, 128
    buffer_load_dwordx4 v2, s[24:27], s69 offen lds
    ds_read_b128 v[240:243], v116
    ds_read_b128 v[244:247], v116 offset:1024
    s_waitcnt lgkmcnt(7)
    v_mfma_f32_32x32x16_bf16 v[64:79], v[28:31], v[128:131], 0
    ds_read_b64_tr_b16 v[40:41], v13 offset:22528
    ds_read_b64_tr_b16 v[42:43], v13 offset:23040
    buffer_load_dwordx4 v3, s[24:27], s69 offen offset:1024 lds
    s_waitcnt lgkmcnt(2)
    v_dot2c_f32_bf16 v112, s11, v240
    v_dot2c_f32_bf16 v113, v240, v240
    v_dot2c_f32_bf16 v114, s11, v244
    v_dot2c_f32_bf16 v115, v244, v244
    v_dot2c_f32_bf16 v112, s11, v241
    v_dot2c_f32_bf16 v113, v241, v241
    v_dot2c_f32_bf16 v114, s11, v245
    v_dot2c_f32_bf16 v115, v245, v245
    v_dot2c_f32_bf16 v112, s11, v242
    v_dot2c_f32_bf16 v113, v242, v242
    v_dot2c_f32_bf16 v114, s11, v246
    v_dot2c_f32_bf16 v115, v246, v246
    v_dot2c_f32_bf16 v112, s11, v243
    v_dot2c_f32_bf16 v113, v243, v243
    v_dot2c_f32_bf16 v114, s11, v247
    v_dot2c_f32_bf16 v115, v247, v247
    v_mfma_f32_32x32x16_bf16 v[80:95], v[32:35], v[128:131], 0
    ds_read_b64_tr_b16 v[44:45], v14 offset:24576
    ds_read_b64_tr_b16 v[46:47], v14 offset:25088
    s_cmp_lg_u32 s88, 0
    s_cbranch_scc1 L_cs_4
    v_mfma_f32_16x16x32_bf16 v[100:103], v[96:99], v[24:27], 0
    v_mfma_f32_16x16x32_bf16 v[104:107], v[96:99], v[28:31], 0
    v_mfma_f32_16x16x32_bf16 v[108:111], v[96:99], v[32:35], 0
L_cs_4:
    v_mfma_f32_32x32x16_bf16 v[48:63], v[36:39], v[132:135], v[48:63]
    ds_read_b128 v[136:139], v10
    ds_read_b64_tr_b16 v[24:25], v12 offset:28672
    ds_read_b64_tr_b16 v[26:27], v12 offset:29184
    s_add_u32 m0, s77, 0x18000
    s_add_u32 s70, s70, 0x38000
    buffer_load_dwordx4 v4, s[28:31], s70 offen lds
    s_waitcnt lgkmcnt(5)
    v_mfma_f32_32x32x16_bf16 v[64:79], v[40:43], v[132:135], v[64:79]
    ds_read_b64_tr_b16 v[28:29], v13 offset:28672
    ds_read_b64_tr_b16 v[30:31], v13 offset:29184
    s_waitcnt lgkmcnt(5)
    v_mfma_f32_32x32x16_bf16 v[80:95], v[44:47], v[132:135], v[80:95]
    ds_read_b64_tr_b16 v[32:33], v14 offset:30720
    ds_read_b64_tr_b16 v[34:35], v14 offset:31232
    buffer_load_dwordx4 v5, s[32:35], s70 offen offset:1024 lds
    s_cmp_lg_u32 s88, 1
    s_cbranch_scc1 L_cs_5
    v_mfma_f32_16x16x32_bf16 v[100:103], v[96:99], v[36:39], 0
    v_mfma_f32_16x16x32_bf16 v[104:107], v[96:99], v[40:43], 0
    v_mfma_f32_16x16x32_bf16 v[108:111], v[96:99], v[44:47], 0
L_cs_5:
    s_waitcnt lgkmcnt(4)
    v_mfma_f32_32x32x16_bf16 v[48:63], v[24:27], v[136:139], v[48:63]
    ds_read_b128 v[140:143], v11
    ds_read_b64_tr_b16 v[36:37], v12 offset:34816
    ds_read_b64_tr_b16 v[38:39], v12 offset:35328
    s_waitcnt lgkmcnt(5)
    v_mfma_f32_32x32x16_bf16 v[64:79], v[28:31], v[136:139], v[64:79]
    ds_read_b64_tr_b16 v[40:41], v13 offset:34816
    ds_read_b64_tr_b16 v[42:43], v13 offset:35328
    s_add_u32 s72, s72, 0x2a000
    buffer_load_dwordx4 v6, s[36:39], s72 offen offset:2048 lds
    s_waitcnt lgkmcnt(5)
    v_mfma_f32_32x32x16_bf16 v[80:95], v[32:35], v[136:139], v[80:95]
    ds_read_b64_tr_b16 v[44:45], v14 offset:36864
    ds_read_b64_tr_b16 v[46:47], v14 offset:37376
    s_cmp_lg_u32 s88, 2
    s_cbranch_scc1 L_cs_6
    v_mfma_f32_16x16x32_bf16 v[100:103], v[96:99], v[24:27], 0
    v_mfma_f32_16x16x32_bf16 v[104:107], v[96:99], v[28:31], 0
    v_mfma_f32_16x16x32_bf16 v[108:111], v[96:99], v[32:35], 0
L_cs_6:
    s_waitcnt lgkmcnt(4)
    v_mfma_f32_32x32x16_bf16 v[48:63], v[36:39], v[140:143], v[48:63]
    s_add_u32 m0, s68, 0x1e000
    s_add_u32 s69, s69, 128
    buffer_load_dwordx4 v2, s[24:27], s69 offen lds
    buffer_load_dwordx4 v3, s[24:27], s69 offen offset:1024 lds
    s_waitcnt vmcnt(7) lgkmcnt(0)
    s_barrier
    ds_read_b128 v[144:147], v8 offset:40960
    v_add_u32 v12, 0xe000, v12
    v_add_u32 v13, 0xe000, v13
    v_add_u32 v14, 0xe000, v14
    ds_read_b64_tr_b16 v[24:25], v12
    ds_read_b64_tr_b16 v[26:27], v12 offset:512
    s_add_u32 m0, s77, 0x0
    s_add_u32 s70, s70, 0x38000
    buffer_load_dwordx4 v4, s[28:31], s70 offen lds
    v_mfma_f32_32x32x16_bf16 v[64:79], v[40:43], v[140:143], v[64:79]
    ds_read_b64_tr_b16 v[28:29], v13
    ds_read_b64_tr_b16 v[30:31], v13 offset:512
    v_mfma_f32_32x32x16_bf16 v[80:95], v[44:47], v[140:143], v[80:95]
    ds_read_b64_tr_b16 v[32:33], v14 offset:2048
    ds_read_b64_tr_b16 v[34:35], v14 offset:2560
    buffer_load_dwordx4 v5, s[32:35], s70 offen offset:1024 lds
    s_cmp_lg_u32 s88, 3
    s_cbranch_scc1 L_cs_7
    v_mfma_f32_16x16x32_bf16 v[100:103], v[96:99], v[36:39], 0
    v_mfma_f32_16x16x32_bf16 v[104:107], v[96:99], v[40:43], 0
    v_mfma_f32_16x16x32_bf16 v[108:111], v[96:99], v[44:47], 0
L_cs_7:
    s_waitcnt lgkmcnt(4)
    v_mfma_f32_32x32x16_bf16 v[48:63], v[24:27], v[144:147], v[48:63]
    ds_read_b128 v[148:151], v9 offset:40960
    ds_read_b64_tr_b16 v[36:37], v12 offset:6144
    ds_read_b64_tr_b16 v[38:39], v12 offset:6656
    ds_read_b128 v[240:243], v116 offset:40960
    ds_read_b128 v[244:247], v116 offset:41984
    s_waitcnt lgkmcnt(7)
    v_mfma_f32_32x32x16_bf16 v[64:79], v[28:31], v[144:147], v[64:79]
    ds_read_b64_tr_b16 v[40:41], v13 offset:6144
    ds_read_b64_tr_b16 v[42:43], v13 offset:6656
    s_add_u32 s72, s72, 0x2a000
    buffer_load_dwordx4 v6, s[36:39], s72 offen offset:2048 lds
    s_waitcnt lgkmcnt(2)
    v_dot2c_f32_bf16 v112, s11, v240
    v_dot2c_f32_bf16 v113, v240, v240
    v_dot2c_f32_bf16 v114, s11, v244
    v_dot2c_f32_bf16 v115, v244, v244
    v_dot2c_f32_bf16 v112, s11, v241
    v_dot2c_f32_bf16 v113, v241, v241
    v_dot2c_f32_bf16 v114, s11, v245
    v_dot2c_f32_bf16 v115, v245, v245
    v_dot2c_f32_bf16 v112, s11, v242
    v_dot2c_f32_bf16 v113, v242, v242
    v_dot2c_f32_bf16 v114, s11, v246
    v_dot2c_f32_bf16 v115, v246, v246
    v_dot2c_f32_bf16 v112, s11, v243
    v_dot2c_f32_bf16 v113, v243, v243
    v_dot2c_f32_bf16 v114, s11, v247
    v_dot2c_f32_bf16 v115, v247, v247
    v_mfma_f32_32x32x16_bf16 v[80:95], v[32:35], v[144:147], v[80:95]
    ds_read_b64_tr_b16 v[44:45], v14 offset:8192
    ds_read_b64_tr_b16 v[46:47], v14 offset:8704
    s_cmp_lg_u32 s88, 0
    s_cbranch_scc1 L_cs_8
    v_mfma_f32_16x16x32_bf16 v[100:103], v[96:99], v[24:27], v[100:103]
    v_mfma_f32_16x16x32_bf16 v[104:107], v[96:99], v[28:31], v[104:107]
    v_mfma_f32_16x16x32_bf16 v[108:111], v[96:99], v[32:35], v[108:111]
L_cs_8:
    v_mfma_f32_32x32x16_bf16 v[48:63], v[36:39], v[148:151], v[48:63]
    ds_read_b128 v[152:155], v10 offset:40960
    ds_read_b64_tr_b16 v[24:25], v12 offset:12288
    ds_read_b64_tr_b16 v[26:27], v12 offset:12800
    s_add_u32 m0, s68, 0x6000
    s_add_u32 s69, s69, 128
    buffer_load_dwordx4 v2, s[24:27], s69 offen lds
    s_waitcnt lgkmcnt(5)
    v_mfma_f32_32x32x16_bf16 v[64:79], v[40:43], v[148:151], v[64:79]
    ds_read_b64_tr_b16 v[28:29], v13 offset:12288
    ds_read_b64_tr_b16 v[30:31], v13 offset:12800
    s_waitcnt lgkmcnt(5)
    v_mfma_f32_32x32x16_bf16 v[80:95], v[44:47], v[148:151], v[80:95]
    ds_read_b64_tr_b16 v[32:33], v14 offset:14336
    ds_read_b64_tr_b16 v[34:35], v14 offset:14848
    buffer_load_dwordx4 v3, s[24:27], s69 offen offset:1024 lds
    s_cmp_lg_u32 s88, 1
    s_cbranch_scc1 L_cs_9
    v_mfma_f32_16x16x32_bf16 v[100:103], v[96:99], v[36:39], v[100:103]
    v_mfma_f32_16x16x32_bf16 v[104:107], v[96:99], v[40:43], v[104:107]
    v_mfma_f32_16x16x32_bf16 v[108:111], v[96:99], v[44:47], v[108:111]
L_cs_9:
    s_waitcnt lgkmcnt(4)
    v_mfma_f32_32x32x16_bf16 v[48:63], v[24:27], v[152:155], v[48:63]
    ds_read_b128 v[156:159], v11 offset:40960
    ds_read_b64_tr_b16 v[36:37], v12 offset:18432
    ds_read_b64_tr_b16 v[38:39], v12 offset:18944
    s_waitcnt lgkmcnt(5)
    v_mfma_f32_32x32x16_bf16 v[64:79], v[28:31], v[152:155], v[64:79]
    ds_read_b64_tr_b16 v[40:41], v13 offset:18432
    ds_read_b64_tr_b16 v[42:43], v13 offset:18944
    s_waitcnt lgkmcnt(5)
    v_mfma_f32_32x32x16_bf16 v[80:95], v[32:35], v[152:155], v[80:95]
    ds_read_b64_tr_b16 v[44:45], v14 offset:20480
    ds_read_b64_tr_b16 v[46:47], v14 offset:20992
    s_cmp_lg_u32 s88, 2
    s_cbranch_scc1 L_cs_10
    v_mfma_f32_16x16x32_bf16 v[100:103], v[96:99], v[24:27], v[100:103]
    v_mfma_f32_16x16x32_bf16 v[104:107], v[96:99], v[28:31], v[104:107]
    v_mfma_f32_16x16x32_bf16 v[108:111], v[96:99], v[32:35], v[108:111]
L_cs_10:
    s_waitcnt lgkmcnt(4)
    v_mfma_f32_32x32x16_bf16 v[48:63], v[36:39], v[156:159], v[48:63]
    s_waitcnt vmcnt(7) lgkmcnt(0)
    s_barrier
    s_lshl_b32 s81, s2, 3
    s_add_u32 s81, s81, s64
    s_cmp_lg_u32 s81, 7
    s_cbranch_scc1 L_nolead_11
    v_lshlrev_b32 v118, 8, v1
    v_mov_b32 v119, 1
    buffer_store_dword v119, v118, s[56:59], 0 offen sc1
L_nolead_11:
    v_add_u32 v8, 0x14000, v8
    v_add_u32 v9, 0x14000, v9
    v_add_u32 v10, 0x14000, v10
    v_add_u32 v11, 0x14000, v11
    ds_read_b128 v[160:163], v8
    v_add_u32 v12, 0xa000, v12
    v_add_u32 v13, 0xa000, v13
    v_add_u32 v14, 0xa000, v14
    ds_read_b64_tr_b16 v[24:25], v12
    ds_read_b64_tr_b16 v[26:27], v12 offset:512
    s_add_u32 m0, s77, 0xa000
    s_add_u32 s70, s70, 0x38000
    buffer_load_dwordx4 v4, s[28:31], s70 offen lds
    v_mfma_f32_32x32x16_bf16 v[64:79], v[40:43], v[156:159], v[64:79]
    ds_read_b64_tr_b16 v[28:29], v13
    ds_read_b64_tr_b16 v[30:31], v13 offset:512
    v_mfma_f32_32x32x16_bf16 v[80:95], v[44:47], v[156:159], v[80:95]
    ds_read_b64_tr_b16 v[32:33], v14 offset:2048
    ds_read_b64_tr_b16 v[34:35], v14 offset:2560
    buffer_load_dwordx4 v5, s[32:35], s70 offen offset:1024 lds
    s_cmp_lg_u32 s88, 3
    s_cbranch_scc1 L_cs_12
    v_mfma_f32_16x16x32_bf16 v[100:103], v[96:99], v[36:39], v[100:103]
    v_mfma_f32_16x16x32_bf16 v[104:107], v[96:99], v[40:43], v[104:107]
    v_mfma_f32_16x16x32_bf16 v[108:111], v[96:99], v[44:47], v[108:111]
L_cs_12:
    s_waitcnt lgkmcnt(4)
    v_mfma_f32_32x32x16_bf16 v[48:63], v[24:27], v[160:163], v[48:63]
    ds_read_b128 v[164:167], v9
    ds_read_b64_tr_b16 v[36:37], v12 offset:6144
    ds_read_b64_tr_b16 v[38:39], v12 offset:6656
    v_add_u32 v116, 0x14000, v116
    ds_read_b128 v[240:243], v116
    ds_read_b128 v[244:247], v116 offset:1024
    s_waitcnt lgkmcnt(7)
    v_mfma_f32_32x32x16_bf16 v[64:79], v[28:31], v[160:163], v[64:79]
    ds_read_b64_tr_b16 v[40:41], v13 offset:6144
    ds_read_b64_tr_b16 v[42:43], v13 offset:6656
    s_add_u32 s72, s72, 0x2a000
    buffer_load_dwordx4 v6, s[36:39], s72 offen offset:2048 lds
    s_waitcnt lgkmcnt(2)
    v_dot2c_f32_bf16 v112, s11, v240
    v_dot2c_f32_bf16 v113, v240, v240
    v_dot2c_f32_bf16 v114, s11, v244
    v_dot2c_f32_bf16 v115, v244, v244
    v_dot2c_f32_bf16 v112, s11, v241
    v_dot2c_f32_bf16 v113, v241, v241
    v_dot2c_f32_bf16 v114, s11, v245
    v_dot2c_f32_bf16 v115, v245, v245
    v_dot2c_f32_bf16 v112, s11, v242
    v_dot2c_f32_bf16 v113, v242, v242
    v_dot2c_f32_bf16 v114, s11, v246
    v_dot2c_f32_bf16 v115, v246, v246
    v_dot2c_f32_bf16 v112, s11, v243
    v_dot2c_f32_bf16 v113, v243, v243
    v_dot2c_f32_bf16 v114, s11, v247
    v_dot2c_f32_bf16 v115, v247, v247
    v_mfma_f32_32x32x16_bf16 v[80:95], v[32:35], v[160:163], v[80:95]
    ds_read_b64_tr_b16 v[44:45], v14 offset:8192
    ds_read_b64_tr_b16 v[46:47], v14 offset:8704
    s_cmp_lg_u32 s88, 0
    s_cbranch_scc1 L_cs_13
    v_mfma_f32_16x16x32_bf16 v[100:103], v[96:99], v[24:27], v[100:103]
    v_mfma_f32_16x16x32_bf16 v[104:107], v[96:99], v[28:31], v[104:107]
    v_mfma_f32_16x16x32_bf16 v[108:111], v[96:99], v[32:35], v[108:111]
L_cs_13:
    v_mfma_f32_32x32x16_bf16 v[48:63], v[36:39], v[164:167], v[48:63]
    ds_read_b128 v[168:171], v10
    ds_read_b64_tr_b16 v[24:25], v12 offset:12288
    ds_read_b64_tr_b16 v[26:27], v12 offset:12800
    s_add_u32 m0, s68, 0x10000
    s_add_u32 s69, s69, 128
    buffer_load_dwordx4 v2, s[24:27], s69 offen lds
    s_waitcnt lgkmcnt(5)
    v_mfma_f32_32x32x16_bf16 v[64:79], v[40:43], v[164:167], v[64:79]
    ds_read_b64_tr_b16 v[28:29], v13 offset:12288
    ds_read_b64_tr_b16 v[30:31], v13 offset:12800
    s_waitcnt lgkmcnt(5)
    v_mfma_f32_32x32x16_bf16 v[80:95], v[44:47], v[164:167], v[80:95]
    ds_read_b64_tr_b16 v[32:33], v14 offset:14336
    ds_read_b64_tr_b16 v[34:35], v14 offset:14848
    buffer_load_dwordx4 v3, s[24:27], s69 offen offset:1024 lds
    s_cmp_lg_u32 s88, 1
    s_cbranch_scc1 L_cs_14
    v_mfma_f32_16x16x32_bf16 v[100:103], v[96:99], v[36:39], v[100:103]
    v_mfma_f32_16x16x32_bf16 v[104:107], v[96:99], v[40:43], v[104:107]
    v_mfma_f32_16x16x32_bf16 v[108:111], v[96:99], v[44:47], v[108:111]
L_cs_14:
    s_waitcnt lgkmcnt(4)
    v_mfma_f32_32x32x16_bf16 v[48:63], v[24:27], v[168:171], v[48:63]
    ds_read_b128 v[172:175], v11
    ds_read_b64_tr_b16 v[36:37], v12 offset:18432
    ds_read_b64_tr_b16 v[38:39], v12 offset:18944
    s_waitcnt lgkmcnt(5)
    v_mfma_f32_32x32x16_bf16 v[64:79], v[28:31], v[168:171], v[64:79]
    ds_read_b64_tr_b16 v[40:41], v13 offset:18432
    ds_read_b64_tr_b16 v[42:43], v13 offset:18944
    s_waitcnt lgkmcnt(5)
    v_mfma_f32_32x32x16_bf16 v[80:95], v[32:35], v[168:171], v[80:95]
    ds_read_b64_tr_b16 v[44:45], v14 offset:20480
    ds_read_b64_tr_b16 v[46:47], v14 offset:20992
    s_cmp_lg_u32 s88, 2
    s_cbranch_scc1 L_cs_15
    v_mfma_f32_16x16x32_bf16 v[100:103], v[96:99], v[24:27], v[100:103]
    v_mfma_f32_16x16x32_bf16 v[104:107], v[96:99], v[28:31], v[104:107]
    v_mfma_f32_16x16x32_bf16 v[108:111], v[96:99], v[32:35], v[108:111]
L_cs_15:
    s_waitcnt lgkmcnt(4)
    v_mfma_f32_32x32x16_bf16 v[48:63], v[36:39], v[172:175], v[48:63]
    s_waitcnt vmcnt(7) lgkmcnt(0)
    s_barrier
    ds_read_b128 v[176:179], v8 offset:40960
    v_subrev_u32 v12, 0x18000, v12
    v_subrev_u32 v13, 0x18000, v13
    v_subrev_u32 v14, 0x18000, v14
    ds_read_b64_tr_b16 v[24:25], v12
    ds_read_b64_tr_b16 v[26:27], v12 offset:512
    s_add_u32 m0, s77, 0x14000
    s_add_u32 s70, s70, 0x38000
    buffer_load_dwordx4 v4, s[28:31], s70 offen lds
    v_mfma_f32_32x32x16_bf16 v[64:79], v[40:43], v[172:175], v[64:79]
    ds_read_b64_tr_b16 v[28:29], v13
    ds_read_b64_tr_b16 v[30:31], v13 offset:512
    v_mfma_f32_32x32x16_bf16 v[80:95], v[44:47], v[172:175], v[80:95]
    ds_read_b64_tr_b16 v[32:33], v14 offset:2048
    ds_read_b64_tr_b16 v[34:35], v14 offset:2560
    buffer_load_dwordx4 v5, s[32:35], s70 offen offset:1024 lds
    s_cmp_lg_u32 s88, 3
    s_cbranch_scc1 L_cs_16
    v_mfma_f32_16x16x32_bf16 v[100:103], v[96:99], v[36:39], v[100:103]
    v_mfma_f32_16x16x32_bf16 v[104:107], v[96:99], v[40:43], v[104:107]
    v_mfma_f32_16x16x32_bf16 v[108:111], v[96:99], v[44:47], v[108:111]
L_cs_16:
    s_cmp_lg_u32 s64, 2
    s_cbranch_scc1 L_warm_17
    v_lshrrev_b32 v118, 4, v1
    v_mul_u32_u24 v118, 3584, v118
    v_and_b32 v119, 15, v1
    v_min_u32 v119, 13, v119
    v_lshl_add_u32 v118, v119, 7, v118
    s_mul_i32 s81, s2, 14336
    s_add_u32 s81, s81, 1792
    s_sub_u32 s82, s81, 1604608
    s_cmp_lt_u32 s2, 112
    s_cselect_b32 s81, s81, s82
    s_cselect_b32 s60, s28, s32
    s_cselect_b32 s61, s29, s33
    s_cselect_b32 s62, s30, s34
    s_mov_b32 s63, 0x20000
    buffer_load_dword v0, v118, s[60:63], s81 offen
L_warm_17:
    s_waitcnt lgkmcnt(4)
    v_mfma_f32_32x32x16_bf16 v[48:63], v[24:27], v[176:179], v[48:63]
    ds_read_b128 v[180:183], v9 offset:40960
    ds_read_b64_tr_b16 v[36:37], v12 offset:6144
    ds_read_b64_tr_b16 v[38:39], v12 offset:6656
    ds_read_b128 v[240:243], v116 offset:40960
    ds_read_b128 v[244:247], v116 offset:41984
    s_waitcnt lgkmcnt(7)
    v_mfma_f32_32x32x16_bf16 v[64:79], v[28:31], v[176:179], v[64:79]
    ds_read_b64_tr_b16 v[40:41], v13 offset:6144
    ds_read_b64_tr_b16 v[42:43], v13 offset:6656
    s_add_u32 s72, s72, 0x2a000
    buffer_load_dwordx4 v6, s[36:39], s72 offen offset:2048 lds
    s_waitcnt lgkmcnt(2)
    v_dot2c_f32_bf16 v112, s11, v240
    v_dot2c_f32_bf16 v113, v240, v240
    v_dot2c_f32_bf16 v114, s11, v244
    v_dot2c_f32_bf16 v115, v244, v244
    v_dot2c_f32_bf16 v112, s11, v241
    v_dot2c_f32_bf16 v113, v241, v241
    v_dot2c_f32_bf16 v114, s11, v245
    v_dot2c_f32_bf16 v115, v245, v245
    v_dot2c_f32_bf16 v112, s11, v242
    v_dot2c_f32_bf16 v113, v242, v242
    v_dot2c_f32_bf16 v114, s11, v246
    v_dot2c_f32_bf16 v115, v246, v246
    v_dot2c_f32_bf16 v112, s11, v243
    v_dot2c_f32_bf16 v113, v243, v243
    v_dot2c_f32_bf16 v114, s11, v247
    v_dot2c_f32_bf16 v115, v247, v247
    v_mfma_f32_32x32x16_bf16 v[80:95], v[32:35], v[176:179], v[80:95]
    ds_read_b64_tr_b16 v[44:45], v14 offset:8192
    ds_read_b64_tr_b16 v[46:47], v14 offset:8704
    s_cmp_lg_u32 s88, 0
    s_cbranch_scc1 L_cs_18
    v_mfma_f32_16x16x32_bf16 v[100:103], v[96:99], v[24:27], v[100:103]
    v_mfma_f32_16x16x32_bf16 v[104:107], v[96:99], v[28:31], v[104:107]
    v_mfma_f32_16x16x32_bf16 v[108:111], v[96:99], v[32:35], v[108:111]
L_cs_18:
    v_mfma_f32_32x32x16_bf16 v[48:63], v[36:39], v[180:183], v[48:63]
    ds_read_b128 v[184:187], v10 offset:40960
    ds_read_b64_tr_b16 v[24:25], v12 offset:12288
    ds_read_b64_tr_b16 v[26:27], v12 offset:12800
    s_add_u32 m0, s68, 0x1a000
    s_add_u32 s69, s69, 128
    buffer_load_dwordx4 v2, s[24:27], s69 offen lds
    s_waitcnt lgkmcnt(5)
    v_mfma_f32_32x32x16_bf16 v[64:79], v[40:43], v[180:183], v[64:79]
    ds_read_b64_tr_b16 v[28:29], v13 offset:12288
    ds_read_b64_tr_b16 v[30:31], v13 offset:12800
    s_waitcnt lgkmcnt(5)
    v_mfma_f32_32x32x16_bf16 v[80:95], v[44:47], v[180:183], v[80:95]
    ds_read_b64_tr_b16 v[32:33], v14 offset:14336
    ds_read_b64_tr_b16 v[34:35], v14 offset:14848
    buffer_load_dwordx4 v3, s[24:27], s69 offen offset:1024 lds
    s_cmp_lg_u32 s88, 1
    s_cbranch_scc1 L_cs_19
    v_mfma_f32_16x16x32_bf16 v[100:103], v[96:99], v[36:39], v[100:103]
    v_mfma_f32_16x16x32_bf16 v[104:107], v[96:99], v[40:43], v[104:107]
    v_mfma_f32_16x16x32_bf16 v[108:111], v[96:99], v[44:47], v[108:111]
L_cs_19:
    s_waitcnt lgkmcnt(4)
    v_mfma_f32_32x32x16_bf16 v[48:63], v[24:27], v[184:187], v[48:63]
    ds_read_b128 v[188:191], v11 offset:40960
    ds_read_b64_tr_b16 v[36:37], v12 offset:18432
    ds_read_b64_tr_b16 v[38:39], v12 offset:18944
    s_waitcnt lgkmcnt(5)
    v_mfma_f32_32x32x16_bf16 v[64:79], v[28:31], v[184:187], v[64:79]
    ds_read_b64_tr_b16 v[40:41], v13 offset:18432
    ds_read_b64_tr_b16 v[42:43], v13 offset:18944
    s_waitcnt lgkmcnt(5)
    v_mfma_f32_32x32x16_bf16 v[80:95], v[32:35], v[184:187], v[80:95]
    ds_read_b64_tr_b16 v[44:45], v14 offset:20480
    ds_read_b64_tr_b16 v[46:47], v14 offset:20992
    s_cmp_lg_u32 s88, 2
    s_cbranch_scc1 L_cs_20
    v_mfma_f32_16x16x32_bf16 v[100:103], v[96:99], v[24:27], v[100:103]
    v_mfma_f32_16x16x32_bf16 v[104:107], v[96:99], v[28:31], v[104:107]
    v_mfma_f32_16x16x32_bf16 v[108:111], v[96:99], v[32:35], v[108:111]
L_cs_20:
    s_waitcnt lgkmcnt(4)
    v_mfma_f32_32x32x16_bf16 v[48:63], v[36:39], v[188:191], v[48:63]
    s_waitcnt vmcnt(7) lgkmcnt(0)
    s_barrier
    v_subrev_u32 v8, 0xe000, v8
    v_subrev_u32 v9, 0xe000, v9
    v_subrev_u32 v10, 0xe000, v10
    v_subrev_u32 v11, 0xe000, v11
    ds_read_b128 v[192:195], v8
    v_add_u32 v12, 0xa000, v12
    v_add_u32 v13, 0xa000, v13
    v_add_u32 v14, 0xa000, v14
    ds_read_b64_tr_b16 v[24:25], v12
    ds_read_b64_tr_b16 v[26:27], v12 offset:512
    s_add_u32 m0, s77, 0x0
    s_add_u32 s70, s70, 0x38000
    buffer_load_dwordx4 v4, s[28:31], s70 offen lds
    v_mfma_f32_32x32x16_bf16 v[64:79], v[40:43], v[188:191], v[64:79]
    ds_read_b64_tr_b16 v[28:29], v13
    ds_read_b64_tr_b16 v[30:31], v13 offset:512
    v_mfma_f32_32x32x16_bf16 v[80:95], v[44:47], v[188:191], v[80:95]
    ds_read_b64_tr_b16 v[32:33], v14 offset:2048
    ds_read_b64_tr_b16 v[34:35], v14 offset:2560
    buffer_load_dwordx4 v5, s[32:35], s70 offen offset:1024 lds
    s_cmp_lg_u32 s88, 3
    s_cbranch_scc1 L_cs_21
    v_mfma_f32_16x16x32_bf16 v[100:103], v[96:99], v[36:39], v[100:103]
    v_mfma_f32_16x16x32_bf16 v[104:107], v[96:99], v[40:43], v[104:107]
    v_mfma_f32_16x16x32_bf16 v[108:111], v[96:99], v[44:47], v[108:111]
L_cs_21:
    s_waitcnt lgkmcnt(4)
    v_mfma_f32_32x32x16_bf16 v[48:63], v[24:27], v[192:195], v[48:63]
    ds_read_b128 v[196:199], v9
    ds_read_b64_tr_b16 v[36:37], v12 offset:6144
    ds_read_b64_tr_b16 v[38:39], v12 offset:6656
    v_subrev_u32 v116, 0xe000, v116
    ds_read_b128 v[240:243], v116
    ds_read_b128 v[244:247], v116 offset:1024
    s_waitcnt lgkmcnt(7)
    v_mfma_f32_32x32x16_bf16 v[64:79], v[28:31], v[192:195], v[64:79]
    ds_read_b64_tr_b16 v[40:41], v13 offset:6144
    ds_read_b64_tr_b16 v[42:43], v13 offset:6656
    s_add_u32 s72, s72, 0x2a000
    buffer_load_dwordx4 v6, s[36:39], s72 offen offset:2048 lds
    s_waitcnt lgkmcnt(2)
    v_dot2c_f32_bf16 v112, s11, v240
    v_dot2c_f32_bf16 v113, v240, v240
    v_dot2c_f32_bf16 v114, s11, v244
    v_dot2c_f32_bf16 v115, v244, v244
    v_dot2c_f32_bf16 v112, s11, v241
    v_dot2c_f32_bf16 v113, v241, v241
    v_dot2c_f32_bf16 v114, s11, v245
    v_dot2c_f32_bf16 v115, v245, v245
    v_dot2c_f32_bf16 v112, s11, v242
    v_dot2c_f32_bf16 v113, v242, v242
    v_dot2c_f32_bf16 v114, s11, v246
    v_dot2c_f32_bf16 v115, v246, v246
    v_dot2c_f32_bf16 v112, s11, v243
    v_dot2c_f32_bf16 v113, v243, v243
    v_dot2c_f32_bf16 v114, s11, v247
    v_dot2c_f32_bf16 v115, v247, v247
    v_mfma_f32_32x32x16_bf16 v[80:95], v[32:35], v[192:195], v[80:95]
    ds_read_b64_tr_b16 v[44:45], v14 offset:8192
    ds_read_b64_tr_b16 v[46:47], v14 offset:8704
    s_cmp_lg_u32 s88, 0
    s_cbranch_scc1 L_cs_22
    v_mfma_f32_16x16x32_bf16 v[100:103], v[96:99], v[24:27], v[100:103]
    v_mfma_f32_16x16x32_bf16 v[104:107], v[96:99], v[28:31], v[104:107]
    v_mfma_f32_16x16x32_bf16 v[108:111], v[96:99], v[32:35], v[108:111]
L_cs_22:
    v_mfma_f32_32x32x16_bf16 v[48:63], v[36:39], v[196:199], v[48:63]
    ds_read_b128 v[200:203], v10
    ds_read_b64_tr_b16 v[24:25], v12 offset:12288
    ds_read_b64_tr_b16 v[26:27], v12 offset:12800
    s_add_u32 m0, s68, 0x1e000
    s_mov_b32 s70, s75
    buffer_load_dwordx4 v4, s[28:31], s70 offen lds
    s_waitcnt lgkmcnt(5)
    v_mfma_f32_32x32x16_bf16 v[64:79], v[40:43], v[196:199], v[64:79]
    ds_read_b64_tr_b16 v[28:29], v13 offset:12288
    ds_read_b64_tr_b16 v[30:31], v13 offset:12800
    s_waitcnt lgkmcnt(5)
    v_mfma_f32_32x32x16_bf16 v[80:95], v[44:47], v[196:199], v[80:95]
    ds_read_b64_tr_b16 v[32:33], v14 offset:14336
    ds_read_b64_tr_b16 v[34:35], v14 offset:14848
    buffer_load_dwordx4 v5, s[32:35], s70 offen offset:1024 lds
    s_cmp_lg_u32 s88, 1
    s_cbranch_scc1 L_cs_23
    v_mfma_f32_16x16x32_bf16 v[100:103], v[96:99], v[36:39], v[100:103]
    v_mfma_f32_16x16x32_bf16 v[104:107], v[96:99], v[40:43], v[104:107]
    v_mfma_f32_16x16x32_bf16 v[108:111], v[96:99], v[44:47], v[108:111]
L_cs_23:
    s_waitcnt lgkmcnt(4)
    v_mfma_f32_32x32x16_bf16 v[48:63], v[24:27], v[200:203], v[48:63]
    ds_read_b128 v[204:207], v11
    ds_read_b64_tr_b16 v[36:37], v12 offset:18432
    ds_read_b64_tr_b16 v[38:39], v12 offset:18944
    s_waitcnt lgkmcnt(5)
    v_mfma_f32_32x32x16_bf16 v[64:79], v[28:31], v[200:203], v[64:79]
    ds_read_b64_tr_b16 v[40:41], v13 offset:18432
    ds_read_b64_tr_b16 v[42:43], v13 offset:18944
    s_waitcnt lgkmcnt(5)
    v_mfma_f32_32x32x16_bf16 v[80:95], v[32:35], v[200:203], v[80:95]
    ds_read_b64_tr_b16 v[44:45], v14 offset:20480
    ds_read_b64_tr_b16 v[46:47], v14 offset:20992
    s_cmp_lg_u32 s88, 2
    s_cbranch_scc1 L_cs_24
    v_mfma_f32_16x16x32_bf16 v[100:103], v[96:99], v[24:27], v[100:103]
    v_mfma_f32_16x16x32_bf16 v[104:107], v[96:99], v[28:31], v[104:107]
    v_mfma_f32_16x16x32_bf16 v[108:111], v[96:99], v[32:35], v[108:111]
L_cs_24:
    s_waitcnt lgkmcnt(4)
    v_mfma_f32_32x32x16_bf16 v[48:63], v[36:39], v[204:207], v[48:63]
    s_waitcnt vmcnt(7) lgkmcnt(0)
    s_barrier
    s_cmp_lg_u32 s64, 0
    s_cbranch_scc1 L_w0_25
    v_mov_b32 v23, 0
    buffer_load_dword v22, v23, s[56:59], 0 offen sc1
L_w0_25:
    ds_read_b128 v[208:211], v8 offset:40960
    v_add_u32 v12, 0xa000, v12
    v_add_u32 v13, 0xa000, v13
    v_add_u32 v14, 0xa000, v14
    ds_read_b64_tr_b16 v[24:25], v12
    ds_read_b64_tr_b16 v[26:27], v12 offset:512
    s_add_u32 m0, s68, 0x6000
    s_add_u32 s70, s70, 0x38000
    buffer_load_dwordx4 v4, s[28:31], s70 offen lds
    v_mfma_f32_32x32x16_bf16 v[64:79], v[40:43], v[204:207], v[64:79]
    ds_read_b64_tr_b16 v[28:29], v13
    ds_read_b64_tr_b16 v[30:31], v13 offset:512
    v_mfma_f32_32x32x16_bf16 v[80:95], v[44:47], v[204:207], v[80:95]
    ds_read_b64_tr_b16 v[32:33], v14 offset:2048
    ds_read_b64_tr_b16 v[34:35], v14 offset:2560
    buffer_load_dwordx4 v5, s[32:35], s70 offen offset:1024 lds
    s_cmp_lg_u32 s88, 3
    s_cbranch_scc1 L_cs_26
    v_mfma_f32_16x16x32_bf16 v[100:103], v[96:99], v[36:39], v[100:103]
    v_mfma_f32_16x16x32_bf16 v[104:107], v[96:99], v[40:43], v[104:107]
    v_mfma_f32_16x16x32_bf16 v[108:111], v[96:99], v[44:47], v[108:111]
L_cs_26:
    s_cmp_lg_u32 s64, 1
    s_cbranch_scc1 L_warm_27
    v_lshlrev_b32 v118, 7, v1
    s_lshl_b32 s81, s2, 13
    s_sub_u32 s82, s81, 1605632
    s_cmp_lt_u32 s2, 196
    s_cselect_b32 s81, s81, s82
    s_cselect_b32 s60, s16, s8
    s_cselect_b32 s61, s17, s9
    s_mov_b32 s62, 0x62000
    s_cselect_b32 s62, 0x188000, s62
    s_mov_b32 s63, 0x20000
    buffer_load_dword v0, v118, s[60:63], s81 offen
L_warm_27:
    s_waitcnt lgkmcnt(4)
    v_mfma_f32_32x32x16_bf16 v[48:63], v[24:27], v[208:211], v[48:63]
    ds_read_b128 v[212:215], v9 offset:40960
    ds_read_b64_tr_b16 v[36:37], v12 offset:6144
    ds_read_b64_tr_b16 v[38:39], v12 offset:6656
    ds_read_b128 v[240:243], v116 offset:40960
    ds_read_b128 v[244:247], v116 offset:41984
    s_waitcnt lgkmcnt(7)
    v_mfma_f32_32x32x16_bf16 v[64:79], v[28:31], v[208:211], v[64:79]
    ds_read_b64_tr_b16 v[40:41], v13 offset:6144
    ds_read_b64_tr_b16 v[42:43], v13 offset:6656
    s_add_u32 m0, s68, 0xa000
    s_add_u32 s70, s70, 0x38000
    buffer_load_dwordx4 v4, s[28:31], s70 offen lds
    s_waitcnt lgkmcnt(2)
    v_dot2c_f32_bf16 v112, s11, v240
    v_dot2c_f32_bf16 v113, v240, v240
    v_dot2c_f32_bf16 v114, s11, v244
    v_dot2c_f32_bf16 v115, v244, v244
    v_dot2c_f32_bf16 v112, s11, v241
    v_dot2c_f32_bf16 v113, v241, v241
    v_dot2c_f32_bf16 v114, s11, v245
    v_dot2c_f32_bf16 v115, v245, v245
    v_dot2c_f32_bf16 v112, s11, v242
    v_dot2c_f32_bf16 v113, v242, v242
    v_dot2c_f32_bf16 v114, s11, v246
    v_dot2c_f32_bf16 v115, v246, v246
    v_dot2c_f32_bf16 v112, s11, v243
    v_dot2c_f32_bf16 v113, v243, v243
    v_dot2c_f32_bf16 v114, s11, v247
    v_dot2c_f32_bf16 v115, v247, v247
    v_mfma_f32_32x32x16_bf16 v[80:95], v[32:35], v[208:211], v[80:95]
    ds_read_b64_tr_b16 v[44:45], v14 offset:8192
    ds_read_b64_tr_b16 v[46:47], v14 offset:8704
    s_cmp_lg_u32 s88, 0
    s_cbranch_scc1 L_cs_28
    v_mfma_f32_16x16x32_bf16 v[100:103], v[96:99], v[24:27], v[100:103]
    v_mfma_f32_16x16x32_bf16 v[104:107], v[96:99], v[28:31], v[104:107]
    v_mfma_f32_16x16x32_bf16 v[108:111], v[96:99], v[32:35], v[108:111]
L_cs_28:
    v_mfma_f32_32x32x16_bf16 v[48:63], v[36:39], v[212:215], v[48:63]
    ds_read_b128 v[216:219], v10 offset:40960
    ds_read_b64_tr_b16 v[24:25], v12 offset:12288
    ds_read_b64_tr_b16 v[26:27], v12 offset:12800
    buffer_load_dwordx4 v5, s[32:35], s70 offen offset:1024 lds
    s_waitcnt lgkmcnt(5)
    v_mfma_f32_32x32x16_bf16 v[64:79], v[40:43], v[212:215], v[64:79]
    ds_read_b64_tr_b16 v[28:29], v13 offset:12288
    ds_read_b64_tr_b16 v[30:31], v13 offset:12800
    s_waitcnt lgkmcnt(5)
    v_mfma_f32_32x32x16_bf16 v[80:95], v[44:47], v[212:215], v[80:95]
    ds_read_b64_tr_b16 v[32:33], v14 offset:14336
    ds_read_b64_tr_b16 v[34:35], v14 offset:14848
    s_cmp_lg_u32 s88, 1
    s_cbranch_scc1 L_cs_29
    v_mfma_f32_16x16x32_bf16 v[100:103], v[96:99], v[36:39], v[100:103]
    v_mfma_f32_16x16x32_bf16 v[104:107], v[96:99], v[40:43], v[104:107]
    v_mfma_f32_16x16x32_bf16 v[108:111], v[96:99], v[44:47], v[108:111]
L_cs_29:
    s_waitcnt lgkmcnt(4)
    v_mfma_f32_32x32x16_bf16 v[48:63], v[24:27], v[216:219], v[48:63]
    ds_read_b128 v[220:223], v11 offset:40960
    ds_read_b64_tr_b16 v[36:37], v12 offset:18432
    ds_read_b64_tr_b16 v[38:39], v12 offset:18944
    s_waitcnt lgkmcnt(5)
    v_mfma_f32_32x32x16_bf16 v[64:79], v[28:31], v[216:219], v[64:79]
    ds_read_b64_tr_b16 v[40:41], v13 offset:18432
    ds_read_b64_tr_b16 v[42:43], v13 offset:18944
    s_waitcnt lgkmcnt(5)
    v_mfma_f32_32x32x16_bf16 v[80:95], v[32:35], v[216:219], v[80:95]
    ds_read_b64_tr_b16 v[44:45], v14 offset:20480
    ds_read_b64_tr_b16 v[46:47], v14 offset:20992
    s_cmp_lg_u32 s88, 2
    s_cbranch_scc1 L_cs_30
    v_mfma_f32_16x16x32_bf16 v[100:103], v[96:99], v[24:27], v[100:103]
    v_mfma_f32_16x16x32_bf16 v[104:107], v[96:99], v[28:31], v[104:107]
    v_mfma_f32_16x16x32_bf16 v[108:111], v[96:99], v[32:35], v[108:111]
L_cs_30:
    s_waitcnt lgkmcnt(4)
    v_mfma_f32_32x32x16_bf16 v[48:63], v[36:39], v[220:223], v[48:63]
    s_cmp_lg_u32 s64, 0
    s_cbranch_scc1 L_w0_31
    s_mov_b32 s80, 100000
    s_waitcnt vmcnt(4)
L_pspin_32:
    v_cmp_le_u32 vcc, 1, v22
    s_nop 0
    s_cmp_eq_u64 vcc, -1
    s_nop 2
    s_cbranch_scc1 L_w0_31
    buffer_load_dword v22, v23, s[56:59], 0 offen sc1
    s_sub_u32 s80, s80, 1
    s_waitcnt vmcnt(0)
    s_cmp_lg_u32 s80, 0
    s_cbranch_scc1 L_pspin_32
L_w0_31:
    s_waitcnt vmcnt(6) lgkmcnt(0)
    s_barrier
    v_add_u32 v8, 0x14000, v8
    v_add_u32 v9, 0x14000, v9
    v_add_u32 v10, 0x14000, v10
    v_add_u32 v11, 0x14000, v11
    ds_read_b128 v[224:227], v8
    v_subrev_u32 v12, 0x14000, v12
    v_subrev_u32 v13, 0x14000, v13
    v_subrev_u32 v14, 0x14000, v14
    ds_read_b64_tr_b16 v[24:25], v12
    ds_read_b64_tr_b16 v[26:27], v12 offset:512
    s_add_u32 m0, s68, 0xe000
    s_add_u32 s70, s70, 0x38000
    buffer_load_dwordx4 v4, s[28:31], s70 offen lds
    v_mfma_f32_32x32x16_bf16 v[64:79], v[40:43], v[220:223], v[64:79]
    ds_read_b64_tr_b16 v[28:29], v13
    ds_read_b64_tr_b16 v[30:31], v13 offset:512
    v_mfma_f32_32x32x16_bf16 v[80:95], v[44:47], v[220:223], v[80:95]
    ds_read_b64_tr_b16 v[32:33], v14 offset:2048
    ds_read_b64_tr_b16 v[34:35], v14 offset:2560
    buffer_load_dwordx4 v5, s[32:35], s70 offen offset:1024 lds
    s_cmp_lg_u32 s88, 3
    s_cbranch_scc1 L_cs_33
    v_mfma_f32_16x16x32_bf16 v[100:103], v[96:99], v[36:39], v[100:103]
    v_mfma_f32_16x16x32_bf16 v[104:107], v[96:99], v[40:43], v[104:107]
    v_mfma_f32_16x16x32_bf16 v[108:111], v[96:99], v[44:47], v[108:111]
L_cs_33:
    s_waitcnt lgkmcnt(4)
    v_mfma_f32_32x32x16_bf16 v[48:63], v[24:27], v[224:227], v[48:63]
    ds_read_b128 v[228:231], v9
    ds_read_b64_tr_b16 v[36:37], v12 offset:6144
    ds_read_b64_tr_b16 v[38:39], v12 offset:6656
    s_mul_i32 s81, s88, 6144
    v_add_u32 v124, s81, v12
    v_add_u32 v125, s81, v13
    v_add_u32 v126, s81, v14
    ds_read_b64_tr_b16 v[248:249], v124
    ds_read_b64_tr_b16 v[250:251], v124 offset:512
    ds_read_b64_tr_b16 v[252:253], v125
    ds_read_b64_tr_b16 v[254:255], v125 offset:512
    ds_read_b64_tr_b16 v[120:121], v126 offset:2048
    ds_read_b64_tr_b16 v[122:123], v126 offset:2560
    s_waitcnt lgkmcnt(11)
    v_mfma_f32_32x32x16_bf16 v[64:79], v[28:31], v[224:227], v[64:79]
    ds_read_b64_tr_b16 v[40:41], v13 offset:6144
    ds_read_b64_tr_b16 v[42:43], v13 offset:6656
    s_add_u32 m0, s68, 0x12000
    s_add_u32 s70, s70, 0x38000
    buffer_load_dwordx4 v4, s[28:31], s70 offen lds
    s_waitcnt lgkmcnt(11)
    v_mfma_f32_32x32x16_bf16 v[80:95], v[32:35], v[224:227], v[80:95]
    ds_read_b64_tr_b16 v[44:45], v14 offset:8192
    ds_read_b64_tr_b16 v[46:47], v14 offset:8704
    s_waitcnt lgkmcnt(4)
    v_mfma_f32_16x16x32_bf16 v[100:103], v[96:99], v[248:251], v[100:103]
    v_mfma_f32_16x16x32_bf16 v[104:107], v[96:99], v[252:255], v[104:107]
    v_mfma_f32_16x16x32_bf16 v[108:111], v[96:99], v[120:123], v[108:111]
    v_mfma_f32_32x32x16_bf16 v[48:63], v[36:39], v[228:231], v[48:63]
    ds_read_b128 v[232:235], v10
    ds_read_b64_tr_b16 v[24:25], v12 offset:12288
    ds_read_b64_tr_b16 v[26:27], v12 offset:12800
    buffer_load_dwordx4 v5, s[32:35], s70 offen offset:1024 lds
    v_add_u32 v116, 0x14000, v116
    ds_read_b128 v[240:243], v116
    ds_read_b128 v[244:247], v116 offset:1024
    s_waitcnt lgkmcnt(7)
    v_mfma_f32_32x32x16_bf16 v[64:79], v[40:43], v[228:231], v[64:79]
    ds_read_b64_tr_b16 v[28:29], v13 offset:12288
    ds_read_b64_tr_b16 v[30:31], v13 offset:12800
    s_waitcnt lgkmcnt(2)
    v_dot2c_f32_bf16 v112, s11, v240
    v_dot2c_f32_bf16 v113, v240, v240
    v_dot2c_f32_bf16 v114, s11, v244
    v_dot2c_f32_bf16 v115, v244, v244
    v_dot2c_f32_bf16 v112, s11, v241
    v_dot2c_f32_bf16 v113, v241, v241
    v_dot2c_f32_bf16 v114, s11, v245
    v_dot2c_f32_bf16 v115, v245, v245
    v_dot2c_f32_bf16 v112, s11, v242
    v_dot2c_f32_bf16 v113, v242, v242
    v_dot2c_f32_bf16 v114, s11, v246
    v_dot2c_f32_bf16 v115, v246, v246
    v_dot2c_f32_bf16 v112, s11, v243
    v_dot2c_f32_bf16 v113, v243, v243
    v_dot2c_f32_bf16 v114, s11, v247
    v_dot2c_f32_bf16 v115, v247, v247
    v_mfma_f32_32x32x16_bf16 v[80:95], v[44:47], v[228:231], v[80:95]
    ds_read_b64_tr_b16 v[32:33], v14 offset:14336
    ds_read_b64_tr_b16 v[34:35], v14 offset:14848
    v_mfma_f32_32x32x16_bf16 v[48:63], v[24:27], v[232:235], v[48:63]
    ds_read_b128 v[236:239], v11
    ds_read_b64_tr_b16 v[36:37], v12 offset:18432
    ds_read_b64_tr_b16 v[38:39], v12 offset:18944
    v_add_f32 v112, v112, v112 quad_perm:[1,0,3,2]
    v_add_f32 v113, v113, v113 quad_perm:[1,0,3,2]
    v_add_f32 v114, v114, v114 quad_perm:[1,0,3,2]
    v_add_f32 v115, v115, v115 quad_perm:[1,0,3,2]
    v_add_f32 v112, v112, v112 quad_perm:[2,3,0,1]
    v_add_f32 v113, v113, v113 quad_perm:[2,3,0,1]
    v_add_f32 v114, v114, v114 quad_perm:[2,3,0,1]
    v_add_f32 v115, v115, v115 quad_perm:[2,3,0,1]
    s_waitcnt lgkmcnt(5)
    v_mfma_f32_32x32x16_bf16 v[64:79], v[28:31], v[232:235], v[64:79]
    ds_read_b64_tr_b16 v[40:41], v13 offset:18432
    ds_read_b64_tr_b16 v[42:43], v13 offset:18944
    v_add_f32 v112, v112, v112 row_half_mirror
    v_add_f32 v113, v113, v113 row_half_mirror
    v_add_f32 v114, v114, v114 row_half_mirror
    v_add_f32 v115, v115, v115 row_half_mirror
    v_and_b32 v248, 0x38, v1
    s_lshl_b32 s81, s64, 7
    s_add_u32 s81, s81, 0x27800
    v_add_u32 v248, s81, v248
    ds_write_b64 v248, v[112:113]
    ds_write_b64 v248, v[114:115] offset:64
    s_waitcnt lgkmcnt(7)
    v_mfma_f32_32x32x16_bf16 v[80:95], v[32:35], v[232:235], v[80:95]
    ds_read_b64_tr_b16 v[44:45], v14 offset:20480
    ds_read_b64_tr_b16 v[46:47], v14 offset:20992
    v_cvt_pk_bf16_f32 v102, v100, v100
    v_cvt_pk_bf16_f32 v103, v101, v101
    v_cvt_pk_bf16_f32 v106, v104, v104
    v_cvt_pk_bf16_f32 v107, v105, v105
    v_cvt_pk_bf16_f32 v110, v108, v108
    v_cvt_pk_bf16_f32 v111, v109, v109
    v_lshlrev_b32 v102, 16, v102
    v_lshlrev_b32 v103, 16, v103
    s_waitcnt lgkmcnt(6)
    v_mfma_f32_32x32x16_bf16 v[48:63], v[36:39], v[236:239], v[48:63]
    v_lshlrev_b32 v106, 16, v106
    v_lshlrev_b32 v107, 16, v107
    v_lshlrev_b32 v110, 16, v110
    v_lshlrev_b32 v111, 16, v111
    v_sub_f32 v102, v100, v102
    v_sub_f32 v103, v101, v103
    v_sub_f32 v106, v104, v106
    v_sub_f32 v107, v105, v107
    v_sub_f32 v110, v108, v110
    v_sub_f32 v111, v109, v111
    v_cvt_pk_bf16_f32 v100, v100, v102
    v_cvt_pk_bf16_f32 v101, v101, v103
    v_cvt_pk_bf16_f32 v104, v104, v106
    v_cvt_pk_bf16_f32 v105, v105, v107
    v_cvt_pk_bf16_f32 v108, v108, v110
    v_cvt_pk_bf16_f32 v109, v109, v111
    v_and_b32 v118, 15, v1
    s_mul_i32 s81, s87, 2560
    s_lshl2_add_u32 s81, s88, s81
    s_add_u32 s81, s81, 0x26400
    v_lshl_add_u32 v118, v118, 4, s81
    s_mov_b64 exec, 0xffff
    ds_write_b32 v118, v100
    ds_write_b32 v118, v101 offset:256
    ds_write_b32 v118, v104 offset:512
    ds_write_b32 v118, v105 offset:768
    ds_write_b32 v118, v108 offset:1024
    ds_write_b32 v118, v109 offset:1280
    s_mov_b64 exec, -1
    s_waitcnt vmcnt(8) lgkmcnt(0)
    s_barrier
    v_lshrrev_b32 v118, 5, v1
    v_lshlrev_b32 v118, 10, v118
    v_sub_u32 v12, v12, v118
    v_sub_u32 v13, v13, v118
    v_add_u32 v12, 0x1e000, v12
    v_add_u32 v13, 0x1e000, v13
    ds_read_b64_tr_b16 v[24:25], v12
    ds_read_b64_tr_b16 v[26:27], v12 offset:512
    s_add_u32 m0, s68, 0x0
    s_add_u32 s70, s70, 0x38000
    buffer_load_dwordx4 v4, s[28:31], s70 offen lds
    v_mfma_f32_32x32x16_bf16 v[64:79], v[40:43], v[236:239], v[64:79]
    ds_read_b64_tr_b16 v[28:29], v13
    ds_read_b64_tr_b16 v[30:31], v13 offset:512
    v_mfma_f32_32x32x16_bf16 v[80:95], v[44:47], v[236:239], v[80:95]
    buffer_load_dwordx4 v5, s[32:35], s70 offen offset:1024 lds
    v_mov_b32 v8, v96
    v_mov_b32 v9, v97
    v_mov_b32 v10, v98
    v_mov_b32 v11, v99
    s_waitcnt lgkmcnt(2)
    v_mfma_f32_32x32x16_bf16 v[96:111], v[24:27], v[128:131], 0
    ds_read_b64_tr_b16 v[36:37], v12 offset:4096
    ds_read_b64_tr_b16 v[38:39], v12 offset:4608
    v_and_b32 v2, 31, v1
    s_lshl_b32 s81, s88, 8
    s_add_u32 s81, s81, 0x27800
    v_lshl_add_u32 v2, v2, 3, s81
    ds_read_b64 v[18:19], v2
    s_waitcnt lgkmcnt(3)
    v_mfma_f32_32x32x16_bf16 v[112:127], v[28:31], v[128:131], 0
    ds_read_b64_tr_b16 v[40:41], v13 offset:4096
    ds_read_b64_tr_b16 v[42:43], v13 offset:4608
    s_add_u32 m0, s68, 0x16000
    s_add_u32 s70, s70, 0x38000
    buffer_load_dwordx4 v4, s[28:31], s70 offen lds
    s_waitcnt lgkmcnt(2)
    v_mul_f32 v18, 0xbb124925, v18
    v_mov_b32 v21, 0x3727c5ac
    v_cvt_pk_bf16_f32 v252, v18, v18
    v_fmac_f32 v21, 0x3b124925, v19
    v_lshlrev_b32 v253, 16, v252
    v_fma_f32 v20, -v18, v18, v21
    v_sub_f32 v253, v18, v253
    s_cmp_lg_u32 s88, 0
    s_cbranch_scc1 L_cs_34
    v_mfma_f32_16x16x32_bf16 v[32:35], v[8:11], v[24:27], 0
    v_mfma_f32_16x16x32_bf16 v[44:47], v[8:11], v[28:31], 0
L_cs_34:
    v_mfma_f32_32x32x16_bf16 v[96:111], v[36:39], v[132:135], v[96:111]
    ds_read_b64_tr_b16 v[24:25], v12 offset:8192
    ds_read_b64_tr_b16 v[26:27], v12 offset:8704
    v_max_f32 v21, 0x3727c5ac, v20
    v_cvt_pk_bf16_f32 v253, v253, v253
    v_cmp_lt_u32 vcc, 31, v1
    v_rsq_f32 v19, v21
    s_nop 0
    v_cndmask_b32 v252, v252, v253, vcc
    v_mov_b32 v253, v252
    v_mov_b32 v254, v252
    v_mov_b32 v255, v252
    s_waitcnt lgkmcnt(2)
    v_mfma_f32_32x32x16_bf16 v[112:127], v[40:43], v[132:135], v[112:127]
    ds_read_b64_tr_b16 v[28:29], v13 offset:8192
    ds_read_b64_tr_b16 v[30:31], v13 offset:8704
    buffer_load_dwordx4 v5, s[32:35], s70 offen offset:1024 lds
    v_mul_f32 v20, 0xbfb8aa3b, v19
    ds_read_b128 v[248:251], v16 offset:1024
    s_cmp_lg_u32 s88, 1
    s_cbranch_scc1 L_cs_35
    v_mfma_f32_16x16x32_bf16 v[32:35], v[8:11], v[36:39], 0
    v_mfma_f32_16x16x32_bf16 v[44:47], v[8:11], v[40:43], 0
L_cs_35:
    s_waitcnt lgkmcnt(3)
    v_mfma_f32_32x32x16_bf16 v[96:111], v[24:27], v[136:139], v[96:111]
    ds_read_b64_tr_b16 v[36:37], v12 offset:12288
    ds_read_b64_tr_b16 v[38:39], v12 offset:12800
    s_waitcnt lgkmcnt(2)
    v_mfma_f32_32x32x16_bf16 v[80:95], v[248:251], v[252:255], v[80:95]
    v_mfma_f32_32x32x16_bf16 v[112:127], v[28:31], v[136:139], v[112:127]
    ds_read_b64_tr_b16 v[40:41], v13 offset:12288
    ds_read_b64_tr_b16 v[42:43], v13 offset:12800
    ds_read_b128 v[248:251], v16
    s_cmp_lg_u32 s88, 2
    s_cbranch_scc1 L_cs_36
    v_mfma_f32_16x16x32_bf16 v[32:35], v[8:11], v[24:27], 0
    v_mfma_f32_16x16x32_bf16 v[44:47], v[8:11], v[28:31], 0
L_cs_36:
    s_waitcnt lgkmcnt(3)
    v_mfma_f32_32x32x16_bf16 v[96:111], v[36:39], v[140:143], v[96:111]
    s_waitcnt vmcnt(10) lgkmcnt(0)
    s_barrier
    v_subrev_u32 v12, 0x18000, v12
    v_subrev_u32 v13, 0x18000, v13
    ds_read_b64_tr_b16 v[24:25], v12
    ds_read_b64_tr_b16 v[26:27], v12 offset:512
    v_mfma_f32_32x32x16_bf16 v[48:63], v[248:251], v[252:255], v[48:63]
    v_mfma_f32_32x32x16_bf16 v[112:127], v[40:43], v[140:143], v[112:127]
    ds_read_b64_tr_b16 v[28:29], v13
    ds_read_b64_tr_b16 v[30:31], v13 offset:512
    s_mul_i32 s99, s0, 0x3800
    s_add_u32 s99, s99, s93
    s_add_u32 s10, s93, 0x31000
    s_add_u32 m0, s67, 0x4000
    s_nop 0
    buffer_load_dwordx4 v7, s[40:43], s99 offen lds
    ds_read_b128 v[248:251], v16 offset:512
    s_cmp_lg_u32 s88, 3
    s_cbranch_scc1 L_cs_37
    v_mfma_f32_16x16x32_bf16 v[32:35], v[8:11], v[36:39], 0
    v_mfma_f32_16x16x32_bf16 v[44:47], v[8:11], v[40:43], 0
L_cs_37:
    s_waitcnt lgkmcnt(3)
    v_mfma_f32_32x32x16_bf16 v[96:111], v[24:27], v[144:147], v[96:111]
    ds_read_b64_tr_b16 v[36:37], v12 offset:4096
    ds_read_b64_tr_b16 v[38:39], v12 offset:4608
    s_waitcnt lgkmcnt(2)
    v_mfma_f32_32x32x16_bf16 v[64:79], v[248:251], v[252:255], v[64:79]
    v_mfma_f32_32x32x16_bf16 v[112:127], v[28:31], v[144:147], v[112:127]
    ds_read_b64_tr_b16 v[40:41], v13 offset:4096
    ds_read_b64_tr_b16 v[42:43], v13 offset:4608
    s_add_u32 s99, s99, 0x3800
    s_add_u32 m0, s67, 0x21400
    s_nop 0
    buffer_load_dwordx4 v7, s[40:43], s99 offen lds
    v_mul_f32 v80, v19, v80
    v_mul_f32 v81, v19, v81
    v_mul_f32 v82, v19, v82
    v_mul_f32 v83, v19, v83
    v_mul_f32 v84, v19, v84
    v_mul_f32 v85, v19, v85
    v_mul_f32 v86, v19, v86
    v_mul_f32 v87, v19, v87
    s_cmp_lg_u32 s88, 0
    s_cbranch_scc1 L_cs_38
    v_mfma_f32_16x16x32_bf16 v[32:35], v[8:11], v[24:27], v[32:35]
    v_mfma_f32_16x16x32_bf16 v[44:47], v[8:11], v[28:31], v[44:47]
L_cs_38:
    s_waitcnt lgkmcnt(2)
    v_mfma_f32_32x32x16_bf16 v[96:111], v[36:39], v[148:151], v[96:111]
    ds_read_b64_tr_b16 v[24:25], v12 offset:8192
    ds_read_b64_tr_b16 v[26:27], v12 offset:8704
    v_mul_f32 v88, v19, v88
    v_mul_f32 v89, v19, v89
    v_mul_f32 v90, v19, v90
    v_mul_f32 v91, v19, v91
    v_mul_f32 v92, v19, v92
    v_mul_f32 v93, v19, v93
    v_mul_f32 v94, v19, v94
    v_mul_f32 v95, v19, v95
    s_waitcnt lgkmcnt(2)
    v_mfma_f32_32x32x16_bf16 v[112:127], v[40:43], v[148:151], v[112:127]
    ds_read_b64_tr_b16 v[28:29], v13 offset:8192
    ds_read_b64_tr_b16 v[30:31], v13 offset:8704
    s_add_u32 s99, s99, 0x3800
    s_add_u32 m0, s67, 0x23400
    s_nop 0
    buffer_load_dwordx4 v7, s[40:43], s99 offen lds
    v_cvt_pk_bf16_f32 v80, v80, v81
    v_cvt_pk_bf16_f32 v81, v82, v83
    v_cvt_pk_bf16_f32 v82, v84, v85
    v_cvt_pk_bf16_f32 v83, v86, v87
    v_cvt_pk_bf16_f32 v84, v88, v89
    v_cvt_pk_bf16_f32 v85, v90, v91
    v_cvt_pk_bf16_f32 v86, v92, v93
    v_cvt_pk_bf16_f32 v87, v94, v95
    s_cmp_lg_u32 s88, 1
    s_cbranch_scc1 L_cs_39
    v_mfma_f32_16x16x32_bf16 v[32:35], v[8:11], v[36:39], v[32:35]
    v_mfma_f32_16x16x32_bf16 v[44:47], v[8:11], v[40:43], v[44:47]
L_cs_39:
    s_waitcnt lgkmcnt(2)
    v_mfma_f32_32x32x16_bf16 v[96:111], v[24:27], v[152:155], v[96:111]
    ds_read_b64_tr_b16 v[36:37], v12 offset:12288
    ds_read_b64_tr_b16 v[38:39], v12 offset:12800
    buffer_store_dwordx4 v[80:83], v15, s[52:55], s92 offen sc1
    buffer_store_dwordx4 v[84:87], v15, s[52:55], s92 offen offset:1024 sc1
    v_mul_f32 v240, v20, v48
    v_mul_f32 v241, v20, v49
    v_mul_f32 v242, v20, v50
    v_mul_f32 v243, v20, v51
    v_mul_f32 v244, v20, v52
    v_mul_f32 v245, v20, v53
    s_waitcnt lgkmcnt(2)
    v_mfma_f32_32x32x16_bf16 v[112:127], v[28:31], v[152:155], v[112:127]
    ds_read_b64_tr_b16 v[40:41], v13 offset:12288
    ds_read_b64_tr_b16 v[42:43], v13 offset:12800
    v_mul_f32 v246, v20, v54
    v_mul_f32 v247, v20, v55
    v_exp_f32 v240, v240
    v_mul_f32 v48, v48, v56
    v_exp_f32 v241, v241
    v_mul_f32 v49, v49, v57
    s_cmp_lg_u32 s88, 2
    s_cbranch_scc1 L_cs_40
    v_mfma_f32_16x16x32_bf16 v[32:35], v[8:11], v[24:27], v[32:35]
    v_mfma_f32_16x16x32_bf16 v[44:47], v[8:11], v[28:31], v[44:47]
L_cs_40:
    s_waitcnt lgkmcnt(2)
    v_mfma_f32_32x32x16_bf16 v[96:111], v[36:39], v[156:159], v[96:111]
    s_waitcnt vmcnt(13) lgkmcnt(0)
    s_barrier
    ds_read_b64_tr_b16 v[24:25], v12 offset:16384
    ds_read_b64_tr_b16 v[26:27], v12 offset:16896
    v_exp_f32 v242, v242
    v_mul_f32 v50, v50, v58
    v_exp_f32 v243, v243
    v_mul_f32 v51, v51, v59
    v_exp_f32 v244, v244
    v_mfma_f32_32x32x16_bf16 v[112:127], v[40:43], v[156:159], v[112:127]
    ds_read_b64_tr_b16 v[28:29], v13 offset:16384
    ds_read_b64_tr_b16 v[30:31], v13 offset:16896
    s_add_u32 s99, s99, 0x3800
    s_add_u32 m0, s67, 0x6000
    s_nop 0
    buffer_load_dwordx4 v7, s[40:43], s99 offen lds
    v_mul_f32 v52, v52, v60
    v_exp_f32 v245, v245
    v_mul_f32 v53, v53, v61
    v_exp_f32 v246, v246
    v_mul_f32 v54, v54, v62
    v_exp_f32 v247, v247
    s_cmp_lg_u32 s88, 3
    s_cbranch_scc1 L_cs_41
    v_mfma_f32_16x16x32_bf16 v[32:35], v[8:11], v[36:39], v[32:35]
    v_mfma_f32_16x16x32_bf16 v[44:47], v[8:11], v[40:43], v[44:47]
L_cs_41:
    s_waitcnt lgkmcnt(2)
    v_mfma_f32_32x32x16_bf16 v[96:111], v[24:27], v[160:163], v[96:111]
    ds_read_b64_tr_b16 v[36:37], v12 offset:20480
    ds_read_b64_tr_b16 v[38:39], v12 offset:20992
    v_mul_f32 v55, v55, v63
    v_fma_f32 v240, v240, v21, v21
    v_fma_f32 v241, v241, v21, v21
    v_fma_f32 v242, v242, v21, v21
    v_fma_f32 v243, v243, v21, v21
    v_fma_f32 v244, v244, v21, v21
    v_fma_f32 v245, v245, v21, v21
    v_fma_f32 v246, v246, v21, v21
    s_waitcnt lgkmcnt(2)
    v_mfma_f32_32x32x16_bf16 v[112:127], v[28:31], v[160:163], v[112:127]
    ds_read_b64_tr_b16 v[40:41], v13 offset:20480
    ds_read_b64_tr_b16 v[42:43], v13 offset:20992
    s_add_u32 s99, s99, 0x3800
    s_add_u32 m0, s67, 0x8000
    s_nop 0
    buffer_load_dwordx4 v7, s[40:43], s99 offen lds
    v_fma_f32 v247, v247, v21, v21
    v_rcp_f32 v240, v240
    v_rcp_f32 v241, v241
    v_mul_f32 v48, v48, v240
    v_rcp_f32 v242, v242
    s_cmp_lg_u32 s88, 0
    s_cbranch_scc1 L_cs_42
    v_mfma_f32_16x16x32_bf16 v[32:35], v[8:11], v[24:27], v[32:35]
    v_mfma_f32_16x16x32_bf16 v[44:47], v[8:11], v[28:31], v[44:47]
L_cs_42:
    s_waitcnt lgkmcnt(2)
    v_mfma_f32_32x32x16_bf16 v[96:111], v[36:39], v[164:167], v[96:111]
    ds_read_b64_tr_b16 v[24:25], v12 offset:24576
    ds_read_b64_tr_b16 v[26:27], v12 offset:25088
    v_mul_f32 v49, v49, v241
    v_rcp_f32 v243, v243
    v_mul_f32 v50, v50, v242
    v_rcp_f32 v244, v244
    v_mul_f32 v51, v51, v243
    v_rcp_f32 v245, v245
    s_waitcnt lgkmcnt(2)
    v_mfma_f32_32x32x16_bf16 v[112:127], v[40:43], v[164:167], v[112:127]
    ds_read_b64_tr_b16 v[28:29], v13 offset:24576
    ds_read_b64_tr_b16 v[30:31], v13 offset:25088
    v_mul_f32 v52, v52, v244
    v_rcp_f32 v246, v246
    v_mul_f32 v53, v53, v245
    v_rcp_f32 v247, v247
    v_mul_f32 v54, v54, v246
    v_cvt_pk_bf16_f32 v48, v48, v49
    s_cmp_lg_u32 s88, 1
    s_cbranch_scc1 L_cs_43
    v_mfma_f32_16x16x32_bf16 v[32:35], v[8:11], v[36:39], v[32:35]
    v_mfma_f32_16x16x32_bf16 v[44:47], v[8:11], v[40:43], v[44:47]
L_cs_43:
    s_waitcnt lgkmcnt(2)
    v_mfma_f32_32x32x16_bf16 v[96:111], v[24:27], v[168:171], v[96:111]
    ds_read_b64_tr_b16 v[36:37], v12 offset:28672
    ds_read_b64_tr_b16 v[38:39], v12 offset:29184
    v_mul_f32 v55, v55, v247
    v_cvt_pk_bf16_f32 v49, v50, v51
    v_cvt_pk_bf16_f32 v50, v52, v53
    v_cvt_pk_bf16_f32 v51, v54, v55
    buffer_store_dwordx4 v[48:51], v15, s[52:55], s89 offen sc1
    v_mul_f32 v240, v20, v64
    v_mul_f32 v241, v20, v65
    v_mul_f32 v242, v20, v66
    s_waitcnt lgkmcnt(2)
    v_mfma_f32_32x32x16_bf16 v[112:127], v[28:31], v[168:171], v[112:127]
    ds_read_b64_tr_b16 v[40:41], v13 offset:28672
    ds_read_b64_tr_b16 v[42:43], v13 offset:29184
    v_mul_f32 v243, v20, v67
    v_mul_f32 v244, v20, v68
    v_mul_f32 v245, v20, v69
    v_mul_f32 v246, v20, v70
    v_mul_f32 v247, v20, v71
    v_exp_f32 v240, v240
    v_mul_f32 v64, v64, v72
    s_cmp_lg_u32 s88, 2
    s_cbranch_scc1 L_cs_44
    v_mfma_f32_16x16x32_bf16 v[32:35], v[8:11], v[24:27], v[32:35]
    v_mfma_f32_16x16x32_bf16 v[44:47], v[8:11], v[28:31], v[44:47]
L_cs_44:
    s_waitcnt lgkmcnt(2)
    v_mfma_f32_32x32x16_bf16 v[96:111], v[36:39], v[172:175], v[96:111]
    v_exp_f32 v241, v241
    v_mul_f32 v65, v65, v73
    v_exp_f32 v242, v242
    v_mul_f32 v66, v66, v74
    v_exp_f32 v243, v243
    v_mul_f32 v67, v67, v75
    v_exp_f32 v244, v244
    v_mul_f32 v68, v68, v76
    v_exp_f32 v245, v245
    v_mul_f32 v69, v69, v77
    v_exp_f32 v246, v246
    v_mul_f32 v70, v70, v78
    v_exp_f32 v247, v247
    v_mul_f32 v71, v71, v79
    v_fma_f32 v240, v240, v21, v21
    v_fma_f32 v241, v241, v21, v21
    v_fma_f32 v242, v242, v21, v21
    v_fma_f32 v243, v243, v21, v21
    v_fma_f32 v244, v244, v21, v21
    v_fma_f32 v245, v245, v21, v21
    v_fma_f32 v246, v246, v21, v21
    v_fma_f32 v247, v247, v21, v21
    v_rcp_f32 v240, v240
    v_rcp_f32 v241, v241
    v_mul_f32 v64, v64, v240
    v_rcp_f32 v242, v242
    v_mul_f32 v65, v65, v241
    v_rcp_f32 v243, v243
    v_mul_f32 v66, v66, v242
    v_rcp_f32 v244, v244
    v_mul_f32 v67, v67, v243
    v_rcp_f32 v245, v245
    v_mul_f32 v68, v68, v244
    v_rcp_f32 v246, v246
    v_mul_f32 v69, v69, v245
    v_rcp_f32 v247, v247
    v_mul_f32 v70, v70, v246
    v_cvt_pk_bf16_f32 v64, v64, v65
    v_mul_f32 v71, v71, v247
    v_cvt_pk_bf16_f32 v65, v66, v67
    v_cvt_pk_bf16_f32 v66, v68, v69
    v_cvt_pk_bf16_f32 v67, v70, v71
    buffer_store_dwordx4 v[64:67], v15, s[52:55], s89 offen offset:1024 sc1
    s_waitcnt vmcnt(15) lgkmcnt(0)
    s_barrier
    ds_read_b64_tr_b16 v[24:25], v12 offset:32768
    ds_read_b64_tr_b16 v[26:27], v12 offset:33280
    v_mfma_f32_32x32x16_bf16 v[112:127], v[40:43], v[172:175], v[112:127]
    ds_read_b64_tr_b16 v[28:29], v13 offset:32768
    ds_read_b64_tr_b16 v[30:31], v13 offset:33280
    s_add_u32 s99, s99, 0x3800
    s_add_u32 m0, s67, 0xa000
    s_nop 0
    buffer_load_dwordx4 v7, s[40:43], s99 offen lds
    s_cmp_lg_u32 s88, 3
    s_cbranch_scc1 L_cs_45
    v_mfma_f32_16x16x32_bf16 v[32:35], v[8:11], v[36:39], v[32:35]
    v_mfma_f32_16x16x32_bf16 v[44:47], v[8:11], v[40:43], v[44:47]
L_cs_45:
    s_waitcnt lgkmcnt(2)
    v_mfma_f32_32x32x16_bf16 v[96:111], v[24:27], v[176:179], v[96:111]
    ds_read_b64_tr_b16 v[36:37], v12 offset:36864
    ds_read_b64_tr_b16 v[38:39], v12 offset:37376
    s_waitcnt lgkmcnt(2)
    v_mfma_f32_32x32x16_bf16 v[112:127], v[28:31], v[176:179], v[112:127]
    ds_read_b64_tr_b16 v[40:41], v13 offset:36864
    ds_read_b64_tr_b16 v[42:43], v13 offset:37376
    s_add_u32 s99, s99, 0x3800
    s_add_u32 m0, s67, 0xc000
    s_nop 0
    buffer_load_dwordx4 v7, s[40:43], s99 offen lds
    s_cmp_lg_u32 s88, 0
    s_cbranch_scc1 L_cs_46
    v_mfma_f32_16x16x32_bf16 v[32:35], v[8:11], v[24:27], v[32:35]
    v_mfma_f32_16x16x32_bf16 v[44:47], v[8:11], v[28:31], v[44:47]
L_cs_46:
    s_waitcnt lgkmcnt(2)
    v_mfma_f32_32x32x16_bf16 v[96:111], v[36:39], v[180:183], v[96:111]
    ds_read_b64_tr_b16 v[24:25], v12 offset:40960
    ds_read_b64_tr_b16 v[26:27], v12 offset:41472
    s_waitcnt lgkmcnt(2)
    v_mfma_f32_32x32x16_bf16 v[112:127], v[40:43], v[180:183], v[112:127]
    ds_read_b64_tr_b16 v[28:29], v13 offset:40960
    ds_read_b64_tr_b16 v[30:31], v13 offset:41472
    s_cmp_lg_u32 s88, 1
    s_cbranch_scc1 L_cs_47
    v_mfma_f32_16x16x32_bf16 v[32:35], v[8:11], v[36:39], v[32:35]
    v_mfma_f32_16x16x32_bf16 v[44:47], v[8:11], v[40:43], v[44:47]
L_cs_47:
    s_waitcnt lgkmcnt(2)
    v_mfma_f32_32x32x16_bf16 v[96:111], v[24:27], v[184:187], v[96:111]
    ds_read_b64_tr_b16 v[36:37], v12 offset:45056
    ds_read_b64_tr_b16 v[38:39], v12 offset:45568
    s_waitcnt lgkmcnt(2)
    v_mfma_f32_32x32x16_bf16 v[112:127], v[28:31], v[184:187], v[112:127]
    ds_read_b64_tr_b16 v[40:41], v13 offset:45056
    ds_read_b64_tr_b16 v[42:43], v13 offset:45568
    s_cmp_lg_u32 s88, 2
    s_cbranch_scc1 L_cs_48
    v_mfma_f32_16x16x32_bf16 v[32:35], v[8:11], v[24:27], v[32:35]
    v_mfma_f32_16x16x32_bf16 v[44:47], v[8:11], v[28:31], v[44:47]
L_cs_48:
    s_waitcnt lgkmcnt(2)
    v_mfma_f32_32x32x16_bf16 v[96:111], v[36:39], v[188:191], v[96:111]
    s_waitcnt vmcnt(6) lgkmcnt(0)
    s_barrier
    s_cmp_lg_u32 s64, 0
    s_cbranch_scc1 L_w0_49
    v_mov_b32 v2, 0x40000000
    s_lshl_b32 s81, s65, 8
    s_add_u32 s81, s81, 8192
    v_writelane_b32 v2, s81, 0
    v_mov_b32 v3, 1
    buffer_atomic_add v3, v2, s[52:55], 0 offen sc1
L_w0_49:
    v_add_u32 v12, 0xc000, v12
    v_add_u32 v13, 0xc000, v13
    ds_read_b64_tr_b16 v[24:25], v12
    ds_read_b64_tr_b16 v[26:27], v12 offset:512
    v_mfma_f32_32x32x16_bf16 v[112:127], v[40:43], v[188:191], v[112:127]
    ds_read_b64_tr_b16 v[28:29], v13
    ds_read_b64_tr_b16 v[30:31], v13 offset:512
    s_add_u32 s99, s99, 0x3800
    s_add_u32 m0, s67, 0xe000
    s_nop 0
    buffer_load_dwordx4 v7, s[40:43], s99 offen lds
    s_cmp_lg_u32 s88, 3
    s_cbranch_scc1 L_cs_50
    v_mfma_f32_16x16x32_bf16 v[32:35], v[8:11], v[36:39], v[32:35]
    v_mfma_f32_16x16x32_bf16 v[44:47], v[8:11], v[40:43], v[44:47]
L_cs_50:
    s_waitcnt lgkmcnt(2)
    v_mfma_f32_32x32x16_bf16 v[96:111], v[24:27], v[192:195], v[96:111]
    ds_read_b64_tr_b16 v[36:37], v12 offset:4096
    ds_read_b64_tr_b16 v[38:39], v12 offset:4608
    s_lshr_b32 s7, s66, 2
    s_mul_i32 s7, s7, 7
    s_mul_i32 s8, s90, 84
    s_add_u32 s8, s8, s7
    s_lshl_b32 s8, s8, 10
    s_add_u32 s8, s8, 0x80000
    s_mul_i32 s94, s90, 28
    s_add_u32 s94, s94, s7
    s_add_u32 s94, s94, s64
    s_lshl_b32 s94, s94, 10
    s_add_u32 s94, s94, 0xcc0000
    s_cmp_lt_u32 s64, 7
    s_cselect_b32 s94, s94, 0x40000000
    v_lshrrev_b32 v6, 4, v1
    s_add_u32 s4, s8, s67
    s_add_u32 s5, s4, 28672
    s_add_u32 s6, s4, 57344
    v_lshlrev_b32 v6, 9, v6
    s_mul_i32 s9, s87, 28672
    s_add_u32 s9, s9, s8
    v_and_b32 v138, 15, v1
    s_lshl_b32 s7, s88, 11
    s_add_u32 s9, s9, s7
    v_lshl_add_u32 v6, v138, 4, v6
    s_add_u32 s9, s9, 0xffff2000
    s_cmp_eq_u32 s90, 0
    s_cselect_b32 s9, 0x40000000, s9
    v_add_u32 v6, 256, v6
    s_lshr_b32 s16, s64, 1
    s_mul_i32 s16, s16, 7
    s_and_b32 s17, s64, 1
    v_and_b32 v144, 15, v1
    v_lshrrev_b32 v145, 4, v1
    s_mov_b32 s96, 0x1a000
    s_mov_b32 s97, 0x1f400
    v_lshl_add_u32 v146, v145, 1, s16
    s_waitcnt lgkmcnt(2)
    v_mfma_f32_32x32x16_bf16 v[112:127], v[28:31], v[192:195], v[112:127]
    ds_read_b64_tr_b16 v[40:41], v13 offset:4096
    ds_read_b64_tr_b16 v[42:43], v13 offset:4608
    s_add_u32 s99, s99, 0x3800
    s_add_u32 m0, s67, 0x10000
    s_nop 0
    buffer_load_dwordx4 v7, s[40:43], s99 offen lds
    v_lshrrev_b32 v148, 2, v146
    v_lshlrev_b32 v148, 10, v148
    v_and_b32 v147, 1, v146
    v_lshl_or_b32 v148, v147, 9, v148
    v_bfe_u32 v147, v146, 1, 1
    v_lshl_or_b32 v148, v147, 3, v148
    v_add_u32 v146, 1, v146
    s_add_u32 s18, s16, 6
    v_min_u32 v146, s18, v146
    s_cmp_lg_u32 s88, 0
    s_cbranch_scc1 L_cs_51
    v_mfma_f32_16x16x32_bf16 v[32:35], v[8:11], v[24:27], v[32:35]
    v_mfma_f32_16x16x32_bf16 v[44:47], v[8:11], v[28:31], v[44:47]
L_cs_51:
    s_waitcnt lgkmcnt(2)
    v_mfma_f32_32x32x16_bf16 v[96:111], v[36:39], v[196:199], v[96:111]
    ds_read_b64_tr_b16 v[24:25], v12 offset:8192
    ds_read_b64_tr_b16 v[26:27], v12 offset:8704
    v_lshrrev_b32 v149, 2, v146
    v_lshlrev_b32 v149, 10, v149
    v_and_b32 v147, 1, v146
    v_lshl_or_b32 v149, v147, 9, v149
    v_bfe_u32 v147, v146, 1, 1
    v_lshl_or_b32 v149, v147, 3, v149
    v_lshl_add_u32 v146, v144, 1, s17
    v_lshlrev_b32 v146, 4, v146
    s_waitcnt lgkmcnt(2)
    v_mfma_f32_32x32x16_bf16 v[112:127], v[40:43], v[196:199], v[112:127]
    ds_read_b64_tr_b16 v[28:29], v13 offset:8192
    ds_read_b64_tr_b16 v[30:31], v13 offset:8704
    s_add_u32 s99, s99, 0x3800
    buffer_load_dwordx4 v[64:67], v7, s[40:43], s99 offen
    v_add3_u32 v150, v148, v146, s96
    v_add3_u32 v151, v149, v146, s96
    v_add_u32 v155, s16, v145
    v_lshrrev_b32 v160, 2, v155
    v_lshlrev_b32 v160, 10, v160
    v_and_b32 v147, 1, v155
    v_lshl_or_b32 v160, v147, 9, v160
    v_bfe_u32 v147, v155, 1, 1
    s_cmp_lg_u32 s88, 1
    s_cbranch_scc1 L_cs_52
    v_mfma_f32_16x16x32_bf16 v[32:35], v[8:11], v[36:39], v[32:35]
    v_mfma_f32_16x16x32_bf16 v[44:47], v[8:11], v[40:43], v[44:47]
L_cs_52:
    s_waitcnt lgkmcnt(2)
    v_mfma_f32_32x32x16_bf16 v[96:111], v[24:27], v[200:203], v[96:111]
    ds_read_b64_tr_b16 v[36:37], v12 offset:12288
    ds_read_b64_tr_b16 v[38:39], v12 offset:12800
    v_lshl_or_b32 v160, v147, 3, v160
    v_add_u32 v155, 4, v155
    v_lshrrev_b32 v161, 2, v155
    v_lshlrev_b32 v161, 10, v161
    v_and_b32 v147, 1, v155
    v_lshl_or_b32 v161, v147, 9, v161
    v_bfe_u32 v147, v155, 1, 1
    v_lshl_or_b32 v161, v147, 3, v161
    s_waitcnt lgkmcnt(2)
    v_mfma_f32_32x32x16_bf16 v[112:127], v[28:31], v[200:203], v[112:127]
    ds_read_b64_tr_b16 v[40:41], v13 offset:12288
    ds_read_b64_tr_b16 v[42:43], v13 offset:12800
    s_add_u32 s99, s99, 0x3800
    buffer_load_dwordx4 v[68:71], v7, s[40:43], s99 offen
    v_add3_u32 v160, v160, v146, s96
    v_add3_u32 v161, v161, v146, s96
    v_mov_b32 v147, 0x27c00
    v_cmp_gt_u32 s[60:61], 48, v1
    v_and_b32 v146, 255, v146
    s_nop 0
    v_cndmask_b32 v161, v147, v161, s[60:61]
    v_and_b32 v147, 8, v148
    v_lshrrev_b32 v152, 9, v148
    v_lshl_or_b32 v152, v152, 8, v147
    s_cmp_lg_u32 s88, 2
    s_cbranch_scc1 L_cs_53
    v_mfma_f32_16x16x32_bf16 v[32:35], v[8:11], v[24:27], v[32:35]
    v_mfma_f32_16x16x32_bf16 v[44:47], v[8:11], v[28:31], v[44:47]
L_cs_53:
    s_waitcnt lgkmcnt(2)
    v_mfma_f32_32x32x16_bf16 v[96:111], v[36:39], v[204:207], v[96:111]
    s_add_u32 s99, s99, 0x3800
    buffer_load_dwordx4 v[72:75], v7, s[40:43], s99 offen
    s_waitcnt vmcnt(7) lgkmcnt(0)
    s_barrier
    s_cmp_lg_u32 s64, 0
    s_cbranch_scc1 L_w0_54
    v_mov_b32 v2, 0x40000000
    s_lshl_b32 s81, s65, 8
    s_add_u32 s81, s81, 12288
    v_writelane_b32 v2, s81, 0
    v_mov_b32 v3, 1
    buffer_atomic_add v3, v2, s[52:55], 0 offen sc1
L_w0_54:
    v_subrev_u32 v12, 0x12000, v12
    v_subrev_u32 v13, 0x12000, v13
    ds_read_b64_tr_b16 v[24:25], v12
    ds_read_b64_tr_b16 v[26:27], v12 offset:512
    v_and_b32 v147, 8, v149
    v_lshrrev_b32 v153, 9, v149
    v_lshl_or_b32 v153, v153, 8, v147
    v_add3_u32 v152, v152, v146, s97
    v_add3_u32 v153, v153, v146, s97
    v_lshrrev_b32 v154, 2, v1
    v_lshl_add_u32 v154, v154, 1, s17
    v_lshlrev_b32 v154, 4, v154
    v_mfma_f32_32x32x16_bf16 v[112:127], v[40:43], v[204:207], v[112:127]
    ds_read_b64_tr_b16 v[28:29], v13
    ds_read_b64_tr_b16 v[30:31], v13 offset:512
    s_add_u32 s99, s99, 0x3800
    s_add_u32 m0, s67, 0x12000
    s_nop 0
    buffer_load_dwordx4 v7, s[40:43], s99 offen lds
    v_and_b32 v155, 3, v1
    v_add_u32 v155, s16, v155
    v_lshrrev_b32 v156, 2, v155
    v_lshlrev_b32 v156, 10, v156
    v_and_b32 v147, 1, v155
    v_lshl_or_b32 v156, v147, 9, v156
    v_bfe_u32 v147, v155, 1, 1
    v_lshl_or_b32 v156, v147, 3, v156
    s_cmp_lg_u32 s88, 3
    s_cbranch_scc1 L_cs_55
    v_mfma_f32_16x16x32_bf16 v[32:35], v[8:11], v[36:39], v[32:35]
    v_mfma_f32_16x16x32_bf16 v[44:47], v[8:11], v[40:43], v[44:47]
L_cs_55:
    s_waitcnt lgkmcnt(2)
    v_mfma_f32_32x32x16_bf16 v[96:111], v[24:27], v[208:211], v[96:111]
    ds_read_b64_tr_b16 v[36:37], v12 offset:4096
    ds_read_b64_tr_b16 v[38:39], v12 offset:4608
    v_add_u32 v155, 4, v155
    v_min_u32 v155, s18, v155
    v_lshrrev_b32 v157, 2, v155
    v_lshlrev_b32 v157, 10, v157
    v_and_b32 v147, 1, v155
    v_lshl_or_b32 v157, v147, 9, v157
    v_bfe_u32 v147, v155, 1, 1
    v_lshl_or_b32 v157, v147, 3, v157
    s_waitcnt lgkmcnt(2)
    v_mfma_f32_32x32x16_bf16 v[112:127], v[28:31], v[208:211], v[112:127]
    ds_read_b64_tr_b16 v[40:41], v13 offset:4096
    ds_read_b64_tr_b16 v[42:43], v13 offset:4608
    s_add_u32 s99, s99, 0x3800
    s_add_u32 m0, s67, 0x14000
    s_nop 0
    buffer_load_dwordx4 v7, s[40:43], s99 offen lds
    v_and_b32 v147, 8, v156
    v_lshrrev_b32 v158, 9, v156
    v_lshl_or_b32 v158, v158, 8, v147
    v_and_b32 v147, 8, v157
    v_lshrrev_b32 v159, 9, v157
    v_lshl_or_b32 v159, v159, 8, v147
    v_add3_u32 v156, v156, v154, s96
    v_add3_u32 v157, v157, v154, s96
    s_cmp_lg_u32 s88, 0
    s_cbranch_scc1 L_cs_56
    v_mfma_f32_16x16x32_bf16 v[32:35], v[8:11], v[24:27], v[32:35]
    v_mfma_f32_16x16x32_bf16 v[44:47], v[8:11], v[28:31], v[44:47]
L_cs_56:
    s_waitcnt lgkmcnt(2)
    v_mfma_f32_32x32x16_bf16 v[96:111], v[36:39], v[212:215], v[96:111]
    ds_read_b64_tr_b16 v[24:25], v12 offset:8192
    ds_read_b64_tr_b16 v[26:27], v12 offset:8704
    v_and_b32 v154, 255, v154
    v_add3_u32 v158, v158, v154, s97
    v_add3_u32 v159, v159, v154, s97
    v_lshlrev_b32 v146, 2, v145
    v_sub_u32 v146, v146, v144
    v_mov_b32 v147, 0xf149f2ca
    s_cmp_eq_u32 s90, 0
    s_cselect_b32 s19, 64, 9
    v_cmp_le_i32 s[60:61], s19, v146
    v_add_u32 v148, 7, v146
    v_cmp_ge_u32 s[62:63], 7, v148
    v_cndmask_b32 v168, v147, 0, s[60:61]
    s_waitcnt lgkmcnt(2)
    v_mfma_f32_32x32x16_bf16 v[112:127], v[40:43], v[212:215], v[112:127]
    ds_read_b64_tr_b16 v[28:29], v13 offset:8192
    ds_read_b64_tr_b16 v[30:31], v13 offset:8704
    s_add_u32 s93, s93, 0xc4000
    s_mul_i32 s99, s0, 0x3800
    s_add_u32 s99, s99, s93
    s_add_u32 s10, s93, 0x31000
    buffer_load_dwordx4 v[76:79], v7, s[40:43], s99 offen
    s_sub_u32 s19, s19, 1
    v_cndmask_b32 v172, v147, 0, s[62:63]
    v_cmp_le_i32 s[60:61], s19, v146
    v_add_u32 v148, 8, v146
    v_cmp_ge_u32 s[62:63], 7, v148
    v_cndmask_b32 v169, v147, 0, s[60:61]
    s_sub_u32 s19, s19, 1
    v_cndmask_b32 v173, v147, 0, s[62:63]
    v_cmp_le_i32 s[60:61], s19, v146
    v_add_u32 v148, 9, v146
    v_cmp_ge_u32 s[62:63], 7, v148
    v_cndmask_b32 v170, v147, 0, s[60:61]
    s_sub_u32 s19, s19, 1
    v_cndmask_b32 v174, v147, 0, s[62:63]
    v_cmp_le_i32 s[60:61], s19, v146
    v_add_u32 v148, 10, v146
    s_cmp_lg_u32 s88, 1
    s_cbranch_scc1 L_cs_57
    v_mfma_f32_16x16x32_bf16 v[32:35], v[8:11], v[36:39], v[32:35]
    v_mfma_f32_16x16x32_bf16 v[44:47], v[8:11], v[40:43], v[44:47]
L_cs_57:
    s_waitcnt lgkmcnt(2)
    v_mfma_f32_32x32x16_bf16 v[96:111], v[24:27], v[216:219], v[96:111]
    ds_read_b64_tr_b16 v[36:37], v12 offset:12288
    ds_read_b64_tr_b16 v[38:39], v12 offset:12800
    v_cmp_ge_u32 s[62:63], 7, v148
    v_cndmask_b32 v171, v147, 0, s[60:61]
    s_nop 0
    v_cndmask_b32 v175, v147, 0, s[62:63]
    s_lshl1_add_u32 s16, s78, s87
    s_mul_i32 s70, s16, 112
    s_mul_i32 s17, s88, 14
    s_add_u32 s70, s70, s17
    s_lshl_b32 s70, s70, 10
    s_add_u32 s70, s70, 0x5c0000
    s_mul_i32 s91, s16, 28
    s_mul_i32 s17, s88, 7
    s_add_u32 s91, s91, s17
    s_lshl_b32 s91, s91, 10
    s_add_u32 s91, s91, 0xcc0000
    s_lshr_b32 s17, s64, 1
    s_mul_i32 s75, s17, 100352
    s_and_b32 s17, s64, 1
    s_mul_i32 s17, s17, 7168
    s_add_u32 s75, s75, s17
    s_lshl_b32 s17, s79, 7
    s_add_u32 s75, s75, s17
    v_lshrrev_b32 v138, 5, v1
    v_bfe_u32 v139, v1, 2, 2
    v_lshl_add_u32 v138, v138, 2, v139
    v_lshlrev_b32 v138, 7, v138
    v_bfe_u32 v139, v1, 3, 1
    v_lshl_or_b32 v138, v139, 6, v138
    s_waitcnt lgkmcnt(2)
    v_mfma_f32_32x32x16_bf16 v[112:127], v[28:31], v[216:219], v[112:127]
    ds_read_b64_tr_b16 v[40:41], v13 offset:12288
    ds_read_b64_tr_b16 v[42:43], v13 offset:12800
    s_add_u32 s99, s99, 0x3800
    buffer_load_dwordx4 v[80:83], v7, s[40:43], s99 offen
    v_bfe_u32 v139, v1, 4, 1
    v_lshl_or_b32 v138, v139, 5, v138
    v_and_b32 v139, 3, v1
    v_lshl_or_b32 v138, v139, 3, v138
    s_lshl_b32 s17, s88, 11
    v_add_u32 v140, s17, v138
    v_xor_b32 v141, 64, v140
    s_lshl_b32 s17, s64, 13
    v_add_u32 v142, s17, v15
    s_lshl_b32 s17, s87, 15
    s_lshl_b32 s18, s88, 11
    s_add_u32 s17, s17, s18
    v_add_u32 v143, s17, v15
    s_cmp_lg_u32 s88, 2
    s_cbranch_scc1 L_cs_58
    v_mfma_f32_16x16x32_bf16 v[32:35], v[8:11], v[24:27], v[32:35]
    v_mfma_f32_16x16x32_bf16 v[44:47], v[8:11], v[28:31], v[44:47]
L_cs_58:
    s_waitcnt lgkmcnt(2)
    v_mfma_f32_32x32x16_bf16 v[96:111], v[36:39], v[220:223], v[96:111]
    s_add_u32 s99, s99, 0x3800
    buffer_load_dwordx4 v[84:87], v7, s[40:43], s99 offen
    s_waitcnt lgkmcnt(0)
    s_barrier
    s_sub_u32 s83, s65, 1
    s_max_i32 s83, s83, 0
    s_and_b32 s84, s66, 3
    s_cmp_eq_u32 s84, 0
    s_cselect_b32 s83, s83, s65
    s_lshl_b32 s12, s65, 8
    s_add_u32 s12, s12, 8192
    s_lshl_b32 s13, s83, 8
    s_add_u32 s13, s13, 8192
    s_cmp_lg_u32 s64, 0
    s_cbranch_scc1 L_w0_59
    v_mov_b32 v23, s12
    v_writelane_b32 v23, s13, 1
    buffer_load_dword v22, v23, s[52:55], 0 offen sc1
L_w0_59:
    v_add_u32 v12, 0x16000, v12
    v_add_u32 v13, 0x16000, v13
    ds_read_b64_tr_b16 v[24:25], v12
    ds_read_b64_tr_b16 v[26:27], v12 offset:512
    v_add_u32 v5, s67, v15
    v_and_b32 v138, 31, v1
    v_mul_u32_u24 v138, 896, v138
    v_lshrrev_b32 v139, 5, v1
    v_lshl_add_u32 v4, v139, 3, v138
    s_mul_i32 s69, s16, 28672
    s_lshl_b32 s17, s79, 7
    s_add_u32 s69, s69, s17
    s_lshl_b32 s17, s88, 5
    s_add_u32 s69, s69, s17
    v_mfma_f32_32x32x16_bf16 v[112:127], v[40:43], v[220:223], v[112:127]
    ds_read_b64_tr_b16 v[28:29], v13
    ds_read_b64_tr_b16 v[30:31], v13 offset:512
    s_add_u32 s99, s99, 0x3800
    s_add_u32 m0, s67, 0x0
    s_nop 0
    buffer_load_dwordx4 v7, s[40:43], s99 offen lds
    s_cmp_lg_u32 s88, 3
    s_cbranch_scc1 L_cs_60
    v_mfma_f32_16x16x32_bf16 v[32:35], v[8:11], v[36:39], v[32:35]
    v_mfma_f32_16x16x32_bf16 v[44:47], v[8:11], v[40:43], v[44:47]
L_cs_60:
    s_waitcnt lgkmcnt(2)
    v_mfma_f32_32x32x16_bf16 v[96:111], v[24:27], v[224:227], v[96:111]
    ds_read_b64_tr_b16 v[36:37], v12 offset:4096
    ds_read_b64_tr_b16 v[38:39], v12 offset:4608
    s_mul_i32 s81, s88, 4096
    v_add_u32 v136, s81, v12
    v_add_u32 v137, s81, v13
    ds_read_b64_tr_b16 v[128:129], v136
    ds_read_b64_tr_b16 v[130:131], v136 offset:512
    ds_read_b64_tr_b16 v[132:133], v137
    ds_read_b64_tr_b16 v[134:135], v137 offset:512
    s_waitcnt lgkmcnt(6)
    v_mfma_f32_32x32x16_bf16 v[112:127], v[28:31], v[224:227], v[112:127]
    ds_read_b64_tr_b16 v[40:41], v13 offset:4096
    ds_read_b64_tr_b16 v[42:43], v13 offset:4608
    s_add_u32 s99, s99, 0x3800
    s_add_u32 m0, s67, 0x2000
    s_nop 0
    buffer_load_dwordx4 v7, s[40:43], s99 offen lds
    s_waitcnt lgkmcnt(6)
    v_mfma_f32_32x32x16_bf16 v[96:111], v[36:39], v[228:231], v[96:111]
    ds_read_b64_tr_b16 v[24:25], v12 offset:8192
    ds_read_b64_tr_b16 v[26:27], v12 offset:8704
    s_waitcnt lgkmcnt(4)
    v_mfma_f32_16x16x32_bf16 v[32:35], v[8:11], v[128:131], v[32:35]
    v_mfma_f32_16x16x32_bf16 v[44:47], v[8:11], v[132:135], v[44:47]
    s_waitcnt lgkmcnt(2)
    v_mfma_f32_32x32x16_bf16 v[112:127], v[40:43], v[228:231], v[112:127]
    ds_read_b64_tr_b16 v[28:29], v13 offset:8192
    ds_read_b64_tr_b16 v[30:31], v13 offset:8704
    s_add_u32 s99, s99, 0x3800
    buffer_load_dwordx4 v[88:91], v7, s[40:43], s99 offen
    s_waitcnt lgkmcnt(2)
    v_mfma_f32_32x32x16_bf16 v[96:111], v[24:27], v[232:235], v[96:111]
    ds_read_b64_tr_b16 v[36:37], v12 offset:12288
    ds_read_b64_tr_b16 v[38:39], v12 offset:12800
    v_cvt_pk_bf16_f32 v34, v32, v32
    v_cvt_pk_bf16_f32 v35, v33, v33
    v_cvt_pk_bf16_f32 v46, v44, v44
    v_cvt_pk_bf16_f32 v47, v45, v45
    v_lshlrev_b32 v34, 16, v34
    v_lshlrev_b32 v35, 16, v35
    v_lshlrev_b32 v46, 16, v46
    v_lshlrev_b32 v47, 16, v47
    s_waitcnt lgkmcnt(2)
    v_mfma_f32_32x32x16_bf16 v[112:127], v[28:31], v[232:235], v[112:127]
    ds_read_b64_tr_b16 v[40:41], v13 offset:12288
    ds_read_b64_tr_b16 v[42:43], v13 offset:12800
    s_add_u32 s99, s99, 0x3800
    buffer_load_dwordx4 v[92:95], v7, s[40:43], s99 offen
    v_sub_f32 v34, v32, v34
    v_sub_f32 v35, v33, v35
    v_sub_f32 v46, v44, v46
    v_sub_f32 v47, v45, v47
    v_cvt_pk_bf16_f32 v32, v32, v34
    v_cvt_pk_bf16_f32 v33, v33, v35
    v_cvt_pk_bf16_f32 v44, v44, v46
    v_cvt_pk_bf16_f32 v45, v45, v47
    s_waitcnt lgkmcnt(2)
    v_mfma_f32_32x32x16_bf16 v[96:111], v[36:39], v[236:239], v[96:111]
    v_and_b32 v2, 15, v1
    s_mul_i32 s81, s87, 2560
    s_lshl2_add_u32 s81, s88, s81
    s_add_u32 s81, s81, 0x26400
    v_lshl_add_u32 v2, v2, 4, s81
    s_mov_b64 exec, 0xffff
    ds_write_b32 v2, v32 offset:1536
    ds_write_b32 v2, v33 offset:1792
    ds_write_b32 v2, v44 offset:2048
    ds_write_b32 v2, v45 offset:2304
    s_mov_b64 exec, -1
    s_waitcnt lgkmcnt(4)
    v_mfma_f32_32x32x16_bf16 v[112:127], v[40:43], v[236:239], v[112:127]
    s_add_u32 s99, s99, 0x3800
    buffer_load_dwordx4 v[192:195], v7, s[40:43], s99 offen
    s_cmp_lg_u32 s64, 0
    s_cbranch_scc1 L_w0_61
    s_mov_b32 s80, 100000
    s_waitcnt vmcnt(5)
L_pspin_62:
    v_cmp_le_u32 vcc, 16, v22
    s_nop 0
    s_cmp_eq_u64 vcc, -1
    s_nop 2
    s_cbranch_scc1 L_w0_61
    buffer_load_dword v22, v23, s[52:55], 0 offen sc1
    s_sub_u32 s80, s80, 1
    s_waitcnt vmcnt(0)
    s_cmp_lg_u32 s80, 0
    s_cbranch_scc1 L_pspin_62
L_w0_61:
    s_waitcnt lgkmcnt(0)
    s_barrier
    s_cmp_eq_u32 s64, 7
    s_cbranch_scc1 L_att7_63
    s_add_u32 m0, s67, 0x1a000
    s_nop 0
    buffer_load_dwordx4 v15, s[52:55], s4 offen sc1 lds
    s_add_u32 m0, s67, 0x1bc00
    s_nop 0
    buffer_load_dwordx4 v15, s[52:55], s5 offen sc1 lds
    s_add_u32 m0, s67, 0x1d800
    s_nop 0
    buffer_load_dwordx4 v15, s[52:55], s6 offen sc1 lds
L_att7_63:
    s_add_u32 m0, s67, 0x1f400
    s_nop 0
    buffer_load_dwordx4 v6, s[52:55], s9 offen sc1 lds
    s_lshr_b32 s83, s78, 1
    s_lshl_b32 s12, s83, 8
    s_add_u32 s12, s12, 12288
    s_lshl_b32 s13, s83, 8
    s_add_u32 s13, s13, 16384
    s_lshl_b32 s14, s83, 8
    s_add_u32 s14, s14, 20480
    s_cmp_lg_u32 s64, 0
    s_cbranch_scc1 L_w0_64
    v_mov_b32 v23, s12
    buffer_load_dword v22, v23, s[52:55], 0 offen sc1
L_w0_64:
    s_add_u32 s89, s89, 57344
    ds_read_b128 v[248:251], v16 offset:1536
    s_waitcnt lgkmcnt(0)
    v_mfma_f32_32x32x16_bf16 v[96:111], v[248:251], v[252:255], v[96:111]
    ds_read_b128 v[248:251], v16 offset:2048
    s_waitcnt lgkmcnt(0)
    v_mfma_f32_32x32x16_bf16 v[112:127], v[248:251], v[252:255], v[112:127]
    s_nop 8
    v_pk_mul_f32 v[240:241], v[96:97], v[20:21] op_sel_hi:[1,0]
    v_pk_mul_f32 v[242:243], v[98:99], v[20:21] op_sel_hi:[1,0]
    v_pk_mul_f32 v[244:245], v[100:101], v[20:21] op_sel_hi:[1,0]
    v_pk_mul_f32 v[246:247], v[102:103], v[20:21] op_sel_hi:[1,0]
    v_exp_f32 v240, v240
    v_exp_f32 v241, v241
    v_pk_mul_f32 v[96:97], v[96:97], v[104:105]
    v_exp_f32 v242, v242
    v_exp_f32 v243, v243
    v_pk_mul_f32 v[98:99], v[98:99], v[106:107]
    v_exp_f32 v244, v244
    v_exp_f32 v245, v245
    v_pk_mul_f32 v[100:101], v[100:101], v[108:109]
    v_exp_f32 v246, v246
    v_exp_f32 v247, v247
    v_pk_mul_f32 v[102:103], v[102:103], v[110:111]
    v_pk_fma_f32 v[240:241], v[240:241], v[20:21], v[20:21] op_sel:[0,1,1] op_sel_hi:[1,1,1]
    v_pk_fma_f32 v[242:243], v[242:243], v[20:21], v[20:21] op_sel:[0,1,1] op_sel_hi:[1,1,1]
    v_pk_fma_f32 v[244:245], v[244:245], v[20:21], v[20:21] op_sel:[0,1,1] op_sel_hi:[1,1,1]
    v_pk_fma_f32 v[246:247], v[246:247], v[20:21], v[20:21] op_sel:[0,1,1] op_sel_hi:[1,1,1]
    v_rcp_f32 v240, v240
    v_rcp_f32 v241, v241
    v_rcp_f32 v242, v242
    v_rcp_f32 v243, v243
    v_rcp_f32 v244, v244
    v_rcp_f32 v245, v245
    v_rcp_f32 v246, v246
    v_rcp_f32 v247, v247
    v_pk_mul_f32 v[96:97], v[96:97], v[240:241]
    v_pk_mul_f32 v[98:99], v[98:99], v[242:243]
    v_pk_mul_f32 v[100:101], v[100:101], v[244:245]
    v_pk_mul_f32 v[102:103], v[102:103], v[246:247]
    v_cvt_pk_bf16_f32 v96, v96, v97
    v_cvt_pk_bf16_f32 v97, v98, v99
    v_cvt_pk_bf16_f32 v98, v100, v101
    v_cvt_pk_bf16_f32 v99, v102, v103
    buffer_store_dwordx4 v[96:99], v15, s[52:55], s89 offen sc1
    v_pk_mul_f32 v[240:241], v[112:113], v[20:21] op_sel_hi:[1,0]
    v_pk_mul_f32 v[242:243], v[114:115], v[20:21] op_sel_hi:[1,0]
    v_pk_mul_f32 v[244:245], v[116:117], v[20:21] op_sel_hi:[1,0]
    v_pk_mul_f32 v[246:247], v[118:119], v[20:21] op_sel_hi:[1,0]
    v_exp_f32 v240, v240
    v_exp_f32 v241, v241
    v_pk_mul_f32 v[112:113], v[112:113], v[120:121]
    v_exp_f32 v242, v242
    v_exp_f32 v243, v243
    v_pk_mul_f32 v[114:115], v[114:115], v[122:123]
    v_exp_f32 v244, v244
    v_exp_f32 v245, v245
    v_pk_mul_f32 v[116:117], v[116:117], v[124:125]
    v_exp_f32 v246, v246
    v_exp_f32 v247, v247
    v_pk_mul_f32 v[118:119], v[118:119], v[126:127]
    v_pk_fma_f32 v[240:241], v[240:241], v[20:21], v[20:21] op_sel:[0,1,1] op_sel_hi:[1,1,1]
    v_pk_fma_f32 v[242:243], v[242:243], v[20:21], v[20:21] op_sel:[0,1,1] op_sel_hi:[1,1,1]
    v_pk_fma_f32 v[244:245], v[244:245], v[20:21], v[20:21] op_sel:[0,1,1] op_sel_hi:[1,1,1]
    v_pk_fma_f32 v[246:247], v[246:247], v[20:21], v[20:21] op_sel:[0,1,1] op_sel_hi:[1,1,1]
    v_rcp_f32 v240, v240
    v_rcp_f32 v241, v241
    v_rcp_f32 v242, v242
    v_rcp_f32 v243, v243
    v_rcp_f32 v244, v244
    v_rcp_f32 v245, v245
    v_rcp_f32 v246, v246
    v_rcp_f32 v247, v247
    v_pk_mul_f32 v[112:113], v[112:113], v[240:241]
    v_pk_mul_f32 v[114:115], v[114:115], v[242:243]
    v_pk_mul_f32 v[116:117], v[116:117], v[244:245]
    v_pk_mul_f32 v[118:119], v[118:119], v[246:247]
    v_cvt_pk_bf16_f32 v112, v112, v113
    v_cvt_pk_bf16_f32 v113, v114, v115
    v_cvt_pk_bf16_f32 v114, v116, v117
    v_cvt_pk_bf16_f32 v115, v118, v119
    buffer_store_dwordx4 v[112:115], v15, s[52:55], s89 offen offset:1024 sc1
    s_mov_b32 s89, s70
    s_cmp_lg_u32 s64, 0
    s_cbranch_scc1 L_w0_65
    s_mov_b32 s80, 100000
    s_waitcnt vmcnt(2)
L_pspin_66:
    v_cmp_le_u32 vcc, 14, v22
    s_nop 0
    s_cmp_eq_u64 vcc, -1
    s_nop 2
    s_cbranch_scc1 L_w0_65
    buffer_load_dword v22, v23, s[52:55], 0 offen sc1
    s_sub_u32 s80, s80, 1
    s_waitcnt vmcnt(0)
    s_cmp_lg_u32 s80, 0
    s_cbranch_scc1 L_pspin_66
L_w0_65:
    s_waitcnt vmcnt(0)
    s_barrier
    s_cmp_lg_u32 s64, 0
    s_cbranch_scc1 L_w0_67
    v_mov_b32 v32, 0x40000000
    s_lshl_b32 s81, s65, 8
    s_add_u32 s81, s81, 16384
    v_writelane_b32 v32, s81, 0
    v_mov_b32 v33, 1
    buffer_atomic_add v33, v32, s[52:55], 0 offen sc1
L_w0_67:
    s_lshl_b32 s1, s0, 10
    s_add_u32 s1, s1, s89
    s_add_u32 s3, s89, 14336
    buffer_load_dwordx4 v[208:211], v15, s[52:55], s1 offen sc1
    buffer_load_dwordx4 v[212:215], v15, s[52:55], s1 offen offset:1024 sc1
    buffer_load_dwordx4 v[216:219], v15, s[52:55], s1 offen offset:2048 sc1
    buffer_load_dwordx4 v[220:223], v15, s[52:55], s1 offen offset:3072 sc1
    ds_read_b64 v[164:165], v150
    ds_read_b64 v[166:167], v151
    ds_read_b64 v[180:181], v150 offset:7168
    ds_read_b64 v[182:183], v151 offset:7168
    ds_read_b64 v[176:177], v152
    ds_read_b64 v[178:179], v153
    ds_read_b64_tr_b16 v[184:185], v158 offset:4096
    ds_read_b64_tr_b16 v[186:187], v156 offset:14336
    ds_read_b64_tr_b16 v[188:189], v159 offset:4096
    ds_read_b64_tr_b16 v[190:191], v157 offset:14336
    v_cmp_gt_u32 vcc, 48, v1
    s_mov_b32 s84, 0x3e8b97f6
    s_waitcnt lgkmcnt(6)
    v_cndmask_b32 v166, 0, v166, vcc
    v_cndmask_b32 v167, 0, v167, vcc
    s_nop 1
    v_mfma_f32_16x16x32_bf16 v[172:175], v[180:183], v[164:167], v[172:175]
    s_waitcnt lgkmcnt(4)
    v_mfma_f32_16x16x32_bf16 v[168:171], v[176:179], v[164:167], v[168:171]
    s_nop 5
    v_max3_f32 v146, v172, v173, v174
    s_nop 0
    v_max3_f32 v146, v146, v175, v168
    v_max3_f32 v146, v146, v169, v170
    v_max_f32 v146, v146, v171
    v_mov_b32 v147, v146
    s_nop 1
    v_permlane16_swap_b32 v146, v147
    v_max_f32 v146, v146, v147
    v_mov_b32 v147, v146
    s_nop 1
    v_permlane32_swap_b32 v146, v147
    v_max_f32 v146, v146, v147
    v_mul_f32 v146, 0xbe8b97f6, v146
    v_fma_f32 v168, v168, s84, v146
    v_fma_f32 v169, v169, s84, v146
    v_fma_f32 v170, v170, s84, v146
    v_fma_f32 v171, v171, s84, v146
    v_fma_f32 v172, v172, s84, v146
    v_fma_f32 v173, v173, s84, v146
    v_fma_f32 v174, v174, s84, v146
    v_fma_f32 v175, v175, s84, v146
    v_exp_f32 v168, v168
    v_exp_f32 v169, v169
    v_exp_f32 v170, v170
    v_exp_f32 v171, v171
    v_exp_f32 v172, v172
    v_exp_f32 v173, v173
    v_exp_f32 v174, v174
    v_exp_f32 v175, v175
    v_cvt_pk_bf16_f32 v164, v168, v169
    v_cvt_pk_bf16_f32 v165, v170, v171
    v_cvt_pk_bf16_f32 v166, v172, v173
    v_cvt_pk_bf16_f32 v167, v174, v175
    s_waitcnt lgkmcnt(0)
    v_add_f32 v148, v168, v169
    v_mfma_f32_16x16x32_bf16 v[176:179], v[184:187], v[164:167], 0
    v_mfma_f32_16x16x32_bf16 v[180:183], v[188:191], v[164:167], 0
    v_add_f32 v148, v148, v170
    v_add_f32 v148, v148, v171
    v_add_f32 v148, v148, v172
    v_add_f32 v148, v148, v173
    v_add_f32 v148, v148, v174
    v_add_f32 v148, v148, v175
    v_mov_b32 v147, v148
    s_nop 1
    v_permlane16_swap_b32 v148, v147
    v_add_f32 v148, v148, v147
    v_mov_b32 v147, v148
    s_nop 1
    v_permlane32_swap_b32 v148, v147
    v_add_f32 v148, v148, v147
    v_rcp_f32 v148, v148
    s_nop 0
    v_mul_f32 v176, v176, v148
    v_mul_f32 v177, v177, v148
    v_mul_f32 v178, v178, v148
    v_mul_f32 v179, v179, v148
    v_mul_f32 v180, v180, v148
    v_mul_f32 v181, v181, v148
    v_mul_f32 v182, v182, v148
    v_mul_f32 v183, v183, v148
    v_cvt_pk_bf16_f32 v176, v176, v177
    v_cvt_pk_bf16_f32 v177, v178, v179
    v_cvt_pk_bf16_f32 v178, v180, v181
    v_cvt_pk_bf16_f32 v179, v182, v183
    ds_write_b64 v160, v[176:177]
    ds_write_b64 v161, v[178:179]
    s_add_u32 s1, s1, 4096
    buffer_load_dwordx4 v[224:227], v15, s[52:55], s1 offen sc1
    buffer_load_dwordx4 v[228:231], v15, s[52:55], s1 offen offset:1024 sc1
    s_waitcnt lgkmcnt(0)
    s_barrier
    s_add_u32 s81, s67, 0x1a000
    v_add_u32 v32, s81, v15
    ds_read_b128 v[240:243], v32
    s_waitcnt lgkmcnt(0)
    buffer_store_dwordx4 v[240:243], v15, s[52:55], s94 offen sc1
    v_add_u32 v5, 0x16000, v5
    ds_write_b128 v5, v[64:67]
    ds_write_b128 v5, v[68:71] offset:8192
    s_add_u32 s99, s99, 0x3800
    buffer_load_dwordx4 v[196:199], v7, s[40:43], s99 offen
    s_add_u32 s99, s99, 0x3800
    buffer_load_dwordx4 v[200:203], v7, s[40:43], s99 offen
    s_add_u32 s99, s99, 0x3800
    buffer_load_dwordx4 v[204:207], v7, s[40:43], s99 offen
    s_waitcnt lgkmcnt(0)
    s_barrier
    ds_read_b64_tr_b16 v[48:49], v140 offset:16384
    ds_read_b64_tr_b16 v[50:51], v140 offset:17408
    ds_read_b64_tr_b16 v[52:53], v141 offset:16384
    ds_read_b64_tr_b16 v[54:55], v141 offset:17408
    s_waitcnt vmcnt(9) lgkmcnt(2)
    v_mfma_f32_32x32x16_bf16 v[96:111], v[48:51], v[208:211], 0
    v_add_u32 v140, 0x21400, v140
    v_add_u32 v141, 0x21400, v141
    ds_read_b64_tr_b16 v[56:57], v140
    ds_read_b64_tr_b16 v[58:59], v140 offset:1024
    ds_write_b128 v5, v[72:75] offset:16384
    s_waitcnt lgkmcnt(3)
    v_mfma_f32_32x32x16_bf16 v[112:127], v[52:55], v[208:211], 0
    ds_read_b64_tr_b16 v[60:61], v141
    ds_read_b64_tr_b16 v[62:63], v141 offset:1024
    buffer_load_dwordx4 v[232:235], v15, s[52:55], s1 offen offset:2048 sc1
    s_waitcnt vmcnt(9) lgkmcnt(3)
    v_mfma_f32_32x32x16_bf16 v[96:111], v[56:59], v[212:215], v[96:111]
    ds_read_b64_tr_b16 v[48:49], v140 offset:8192
    ds_read_b64_tr_b16 v[50:51], v140 offset:9216
    ds_write_b128 v5, v[76:79] offset:24576
    s_waitcnt lgkmcnt(3)
    v_mfma_f32_32x32x16_bf16 v[112:127], v[60:63], v[212:215], v[112:127]
    ds_read_b64_tr_b16 v[52:53], v141 offset:8192
    ds_read_b64_tr_b16 v[54:55], v141 offset:9216
    buffer_load_dwordx4 v[236:239], v15, s[52:55], s1 offen offset:3072 sc1
    s_waitcnt vmcnt(9) lgkmcnt(3)
    v_mfma_f32_32x32x16_bf16 v[96:111], v[48:51], v[216:219], v[96:111]
    v_subrev_u32 v140, 0x1b400, v140
    v_subrev_u32 v141, 0x1b400, v141
    ds_read_b64_tr_b16 v[56:57], v140
    ds_read_b64_tr_b16 v[58:59], v140 offset:1024
    ds_write_b128 v5, v[80:83] offset:32768
    s_waitcnt lgkmcnt(3)
    v_mfma_f32_32x32x16_bf16 v[112:127], v[52:55], v[216:219], v[112:127]
    ds_read_b64_tr_b16 v[60:61], v141
    ds_read_b64_tr_b16 v[62:63], v141 offset:1024
    s_add_u32 s1, s1, 4096
    buffer_load_dwordx4 v[208:211], v15, s[52:55], s1 offen sc1
    s_waitcnt vmcnt(9) lgkmcnt(3)
    v_mfma_f32_32x32x16_bf16 v[96:111], v[56:59], v[220:223], v[96:111]
    ds_read_b64_tr_b16 v[48:49], v140 offset:8192
    ds_read_b64_tr_b16 v[50:51], v140 offset:9216
    s_waitcnt lgkmcnt(2)
    v_mfma_f32_32x32x16_bf16 v[112:127], v[60:63], v[220:223], v[112:127]
    ds_read_b64_tr_b16 v[52:53], v141 offset:8192
    ds_read_b64_tr_b16 v[54:55], v141 offset:9216
    buffer_load_dwordx4 v[212:215], v15, s[52:55], s1 offen offset:1024 sc1
    s_waitcnt vmcnt(9) lgkmcnt(2)
    v_mfma_f32_32x32x16_bf16 v[96:111], v[48:51], v[224:227], v[96:111]
    ds_read_b64_tr_b16 v[56:57], v140 offset:16384
    ds_read_b64_tr_b16 v[58:59], v140 offset:17408
    s_waitcnt lgkmcnt(2)
    v_mfma_f32_32x32x16_bf16 v[112:127], v[52:55], v[224:227], v[112:127]
    ds_read_b64_tr_b16 v[60:61], v141 offset:16384
    ds_read_b64_tr_b16 v[62:63], v141 offset:17408
    buffer_load_dwordx4 v[216:219], v15, s[52:55], s1 offen offset:2048 sc1
    s_cmp_lg_u32 s64, 0
    s_cbranch_scc1 L_w0_68
    v_mov_b32 v23, s13
    buffer_load_dword v22, v23, s[52:55], 0 offen sc1
L_w0_68:
    s_waitcnt vmcnt(9) lgkmcnt(2)
    v_mfma_f32_32x32x16_bf16 v[96:111], v[56:59], v[228:231], v[96:111]
    ds_read_b64_tr_b16 v[48:49], v140 offset:24576
    ds_read_b64_tr_b16 v[50:51], v140 offset:25600
    s_waitcnt lgkmcnt(2)
    v_mfma_f32_32x32x16_bf16 v[112:127], v[60:63], v[228:231], v[112:127]
    ds_read_b64_tr_b16 v[52:53], v141 offset:24576
    ds_read_b64_tr_b16 v[54:55], v141 offset:25600
    buffer_load_dwordx4 v[220:223], v15, s[52:55], s1 offen offset:3072 sc1
    buffer_load_dwordx2 v[36:37], v4, s[24:27], s69 offen
    buffer_load_dwordx2 v[38:39], v4, s[24:27], s69 offen offset:16
    s_waitcnt vmcnt(7) lgkmcnt(2)
    v_mfma_f32_32x32x16_bf16 v[96:111], v[48:51], v[232:235], v[96:111]
    s_cmp_lg_u32 s64, 0
    s_cbranch_scc1 L_w0_69
    s_mov_b32 s80, 100000
    s_waitcnt vmcnt(3)
L_pspin_70:
    v_cmp_le_u32 vcc, 14, v22
    s_nop 0
    s_cmp_eq_u64 vcc, -1
    s_nop 2
    s_cbranch_scc1 L_w0_69
    buffer_load_dword v22, v23, s[52:55], 0 offen sc1
    s_sub_u32 s80, s80, 1
    s_waitcnt vmcnt(0)
    s_cmp_lg_u32 s80, 0
    s_cbranch_scc1 L_pspin_70
L_w0_69:
    s_waitcnt lgkmcnt(0)
    s_barrier
    s_cmp_lg_u32 s64, 0
    s_cbranch_scc1 L_w0_71
    v_mov_b32 v32, 0x40000000
    s_lshl_b32 s81, s65, 8
    s_add_u32 s81, s81, 20480
    v_writelane_b32 v32, s81, 0
    v_mov_b32 v33, 1
    buffer_atomic_add v33, v32, s[52:55], 0 offen sc1
L_w0_71:
    ds_read_b64_tr_b16 v[56:57], v140 offset:32768
    ds_read_b64_tr_b16 v[58:59], v140 offset:33792
    v_subrev_u32 v5, 0x12000, v5
    ds_write_b128 v5, v[84:87]
    v_mfma_f32_32x32x16_bf16 v[112:127], v[52:55], v[232:235], v[112:127]
    ds_read_b64_tr_b16 v[60:61], v141 offset:32768
    ds_read_b64_tr_b16 v[62:63], v141 offset:33792
    s_add_u32 s1, s1, 4096
    buffer_load_dwordx4 v[224:227], v15, s[52:55], s1 offen sc1
    s_waitcnt vmcnt(7) lgkmcnt(3)
    v_mfma_f32_32x32x16_bf16 v[96:111], v[56:59], v[236:239], v[96:111]
    ds_read_b64_tr_b16 v[48:49], v140 offset:40960
    ds_read_b64_tr_b16 v[50:51], v140 offset:41984
    v_add_u32 v5, 0x1c000, v5
    ds_write_b128 v5, v[88:91]
    s_waitcnt lgkmcnt(3)
    v_mfma_f32_32x32x16_bf16 v[112:127], v[60:63], v[236:239], v[112:127]
    ds_read_b64_tr_b16 v[52:53], v141 offset:40960
    ds_read_b64_tr_b16 v[54:55], v141 offset:41984
    buffer_load_dwordx4 v[228:231], v15, s[52:55], s1 offen offset:1024 sc1
    s_waitcnt vmcnt(7) lgkmcnt(3)
    v_mfma_f32_32x32x16_bf16 v[96:111], v[48:51], v[208:211], v[96:111]
    v_add_u32 v140, 0x10000, v140
    v_add_u32 v141, 0x10000, v141
    ds_read_b64_tr_b16 v[56:57], v140
    ds_read_b64_tr_b16 v[58:59], v140 offset:1024
    ds_write_b128 v5, v[92:95] offset:8192
    s_waitcnt lgkmcnt(3)
    v_mfma_f32_32x32x16_bf16 v[112:127], v[52:55], v[208:211], v[112:127]
    ds_read_b64_tr_b16 v[60:61], v141
    ds_read_b64_tr_b16 v[62:63], v141 offset:1024
    s_add_u32 s89, s89, 57344
    s_lshl_b32 s1, s0, 10
    s_add_u32 s1, s1, s89
    s_add_u32 s3, s89, 14336
    buffer_load_dwordx4 v[232:235], v15, s[52:55], s1 offen sc1
    s_waitcnt vmcnt(7) lgkmcnt(3)
    v_mfma_f32_32x32x16_bf16 v[96:111], v[56:59], v[212:215], v[96:111]
    ds_read_b64_tr_b16 v[48:49], v140 offset:8192
    ds_read_b64_tr_b16 v[50:51], v140 offset:9216
    ds_write_b128 v5, v[192:195] offset:16384
    s_waitcnt lgkmcnt(3)
    v_mfma_f32_32x32x16_bf16 v[112:127], v[60:63], v[212:215], v[112:127]
    ds_read_b64_tr_b16 v[52:53], v141 offset:8192
    ds_read_b64_tr_b16 v[54:55], v141 offset:9216
    buffer_load_dwordx4 v[236:239], v15, s[52:55], s1 offen offset:1024 sc1
    s_waitcnt vmcnt(7) lgkmcnt(3)
    v_mfma_f32_32x32x16_bf16 v[96:111], v[48:51], v[216:219], v[96:111]
    ds_read_b64_tr_b16 v[56:57], v140 offset:16384
    ds_read_b64_tr_b16 v[58:59], v140 offset:17408
    v_subrev_u32 v5, 0x1a000, v5
    ds_write_b128 v5, v[196:199]
    s_waitcnt lgkmcnt(3)
    v_mfma_f32_32x32x16_bf16 v[112:127], v[52:55], v[216:219], v[112:127]
    ds_read_b64_tr_b16 v[60:61], v141 offset:16384
    ds_read_b64_tr_b16 v[62:63], v141 offset:17408
    buffer_load_dwordx4 v[208:211], v15, s[52:55], s1 offen offset:2048 sc1
    s_waitcnt vmcnt(7) lgkmcnt(3)
    v_mfma_f32_32x32x16_bf16 v[96:111], v[56:59], v[220:223], v[96:111]
    v_subrev_u32 v140, 0x4000, v140
    v_subrev_u32 v141, 0x4000, v141
    ds_read_b64_tr_b16 v[48:49], v140
    ds_read_b64_tr_b16 v[50:51], v140 offset:1024
    ds_write_b128 v5, v[200:203] offset:8192
    s_waitcnt lgkmcnt(3)
    v_mfma_f32_32x32x16_bf16 v[112:127], v[60:63], v[220:223], v[112:127]
    ds_read_b64_tr_b16 v[52:53], v141
    ds_read_b64_tr_b16 v[54:55], v141 offset:1024
    buffer_load_dwordx4 v[212:215], v15, s[52:55], s1 offen offset:3072 sc1
    s_waitcnt vmcnt(5) lgkmcnt(3)
    v_mfma_f32_32x32x16_bf16 v[96:111], v[48:51], v[224:227], v[96:111]
    ds_read_b64_tr_b16 v[56:57], v140 offset:8192
    ds_read_b64_tr_b16 v[58:59], v140 offset:9216
    ds_write_b128 v5, v[204:207] offset:16384
    s_waitcnt lgkmcnt(3)
    v_mfma_f32_32x32x16_bf16 v[112:127], v[52:55], v[224:227], v[112:127]
    ds_read_b64_tr_b16 v[60:61], v141 offset:8192
    ds_read_b64_tr_b16 v[62:63], v141 offset:9216
    s_add_u32 s1, s1, 4096
    buffer_load_dwordx4 v[216:219], v15, s[52:55], s1 offen sc1
    s_waitcnt vmcnt(5) lgkmcnt(3)
    v_mfma_f32_32x32x16_bf16 v[96:111], v[56:59], v[228:231], v[96:111]
    s_add_u32 s99, s99, 0x3800
    s_add_u32 m0, s67, 0xc000
    s_nop 0
    buffer_load_dwordx4 v7, s[40:43], s99 offen lds
    s_waitcnt lgkmcnt(0)
    s_barrier
    ds_read_b64_tr_b16 v[48:49], v140 offset:40960
    ds_read_b64_tr_b16 v[50:51], v140 offset:41984
    s_add_u32 s99, s99, 0x3800
    s_add_u32 m0, s67, 0x16400
    s_nop 0
    buffer_load_dwordx4 v7, s[40:43], s99 offen lds
    v_mfma_f32_32x32x16_bf16 v[112:127], v[60:63], v[228:231], v[112:127]
    ds_read_b64_tr_b16 v[52:53], v141 offset:40960
    ds_read_b64_tr_b16 v[54:55], v141 offset:41984
    buffer_load_dwordx4 v[220:223], v15, s[52:55], s1 offen offset:1024 sc1
    s_waitcnt vmcnt(7) lgkmcnt(2)
    v_mfma_f32_32x32x16_bf16 v[96:111], v[48:51], v[232:235], v[96:111]
    ds_read_b64_tr_b16 v[56:57], v140 offset:49152
    ds_read_b64_tr_b16 v[58:59], v140 offset:50176
    s_add_u32 s99, s99, 0x3800
    s_add_u32 m0, s67, 0x18400
    s_nop 0
    buffer_load_dwordx4 v7, s[40:43], s99 offen lds
    s_waitcnt lgkmcnt(2)
    v_mfma_f32_32x32x16_bf16 v[112:127], v[52:55], v[232:235], v[112:127]
    ds_read_b64_tr_b16 v[60:61], v141 offset:49152
    ds_read_b64_tr_b16 v[62:63], v141 offset:50176
    buffer_load_dwordx4 v[224:227], v15, s[52:55], s1 offen offset:2048 sc1
    s_waitcnt vmcnt(8) lgkmcnt(2)
    v_mfma_f32_32x32x16_bf16 v[96:111], v[56:59], v[236:239], v[96:111]
    v_subrev_u32 v140, 0xe000, v140
    v_subrev_u32 v141, 0xe000, v141
    ds_read_b64_tr_b16 v[48:49], v140
    ds_read_b64_tr_b16 v[50:51], v140 offset:1024
    s_mov_b32 s93, s75
    s_mul_i32 s99, s0, 0x1c00
    s_add_u32 s99, s99, s93
    s_add_u32 s10, s93, 0x18800
    s_add_u32 m0, s67, 0xe000
    s_nop 0
    buffer_load_dwordx4 v7, s[44:47], s99 offen lds
    s_waitcnt lgkmcnt(2)
    v_mfma_f32_32x32x16_bf16 v[112:127], v[60:63], v[236:239], v[112:127]
    ds_read_b64_tr_b16 v[52:53], v141
    ds_read_b64_tr_b16 v[54:55], v141 offset:1024
    buffer_load_dwordx4 v[228:231], v15, s[52:55], s1 offen offset:3072 sc1
    s_waitcnt vmcnt(9) lgkmcnt(2)
    v_mfma_f32_32x32x16_bf16 v[96:111], v[48:51], v[208:211], v[96:111]
    v_subrev_u32 v140, 0x4000, v140
    v_subrev_u32 v141, 0x4000, v141
    ds_read_b64_tr_b16 v[56:57], v140
    ds_read_b64_tr_b16 v[58:59], v140 offset:1024
    s_waitcnt lgkmcnt(2)
    v_mfma_f32_32x32x16_bf16 v[112:127], v[52:55], v[208:211], v[112:127]
    ds_read_b64_tr_b16 v[60:61], v141
    ds_read_b64_tr_b16 v[62:63], v141 offset:1024
    s_add_u32 s1, s1, 4096
    buffer_load_dwordx4 v[232:235], v15, s[52:55], s1 offen sc1
    s_waitcnt vmcnt(9) lgkmcnt(2)
    v_mfma_f32_32x32x16_bf16 v[96:111], v[56:59], v[212:215], v[96:111]
    ds_read_b64_tr_b16 v[48:49], v140 offset:8192
    ds_read_b64_tr_b16 v[50:51], v140 offset:9216
    s_waitcnt lgkmcnt(2)
    v_mfma_f32_32x32x16_bf16 v[112:127], v[60:63], v[212:215], v[112:127]
    ds_read_b64_tr_b16 v[52:53], v141 offset:8192
    ds_read_b64_tr_b16 v[54:55], v141 offset:9216
    buffer_load_dwordx4 v[236:239], v15, s[52:55], s1 offen offset:1024 sc1
    s_waitcnt vmcnt(9) lgkmcnt(2)
    v_mfma_f32_32x32x16_bf16 v[96:111], v[48:51], v[216:219], v[96:111]
    v_add_u32 v140, 0x20000, v140
    v_add_u32 v141, 0x20000, v141
    ds_read_b64_tr_b16 v[56:57], v140
    ds_read_b64_tr_b16 v[58:59], v140 offset:1024
    s_waitcnt lgkmcnt(2)
    v_mfma_f32_32x32x16_bf16 v[112:127], v[52:55], v[216:219], v[112:127]
    ds_read_b64_tr_b16 v[60:61], v141
    ds_read_b64_tr_b16 v[62:63], v141 offset:1024
    buffer_load_dwordx4 v[208:211], v15, s[52:55], s1 offen offset:2048 sc1
    s_waitcnt vmcnt(7) lgkmcnt(2)
    v_mfma_f32_32x32x16_bf16 v[96:111], v[56:59], v[220:223], v[96:111]
    ds_read_b64_tr_b16 v[48:49], v140 offset:8192
    ds_read_b64_tr_b16 v[50:51], v140 offset:9216
    s_waitcnt lgkmcnt(2)
    v_mfma_f32_32x32x16_bf16 v[112:127], v[60:63], v[220:223], v[112:127]
    ds_read_b64_tr_b16 v[52:53], v141 offset:8192
    ds_read_b64_tr_b16 v[54:55], v141 offset:9216
    buffer_load_dwordx4 v[212:215], v15, s[52:55], s1 offen offset:3072 sc1
    s_waitcnt vmcnt(6) lgkmcnt(2)
    v_mfma_f32_32x32x16_bf16 v[96:111], v[48:51], v[224:227], v[96:111]
    s_waitcnt lgkmcnt(0)
    s_barrier
    ds_read_b64_tr_b16 v[56:57], v140 offset:16384
    ds_read_b64_tr_b16 v[58:59], v140 offset:17408
    s_add_u32 s99, s99, 0x3800
    s_add_u32 m0, s67, 0x0
    s_nop 0
    buffer_load_dwordx4 v7, s[44:47], s99 offen lds
    v_mfma_f32_32x32x16_bf16 v[112:127], v[52:55], v[224:227], v[112:127]
    ds_read_b64_tr_b16 v[60:61], v141 offset:16384
    ds_read_b64_tr_b16 v[62:63], v141 offset:17408
    s_add_u32 s1, s1, 4096
    buffer_load_dwordx4 v[216:219], v15, s[52:55], s1 offen sc1
    s_cmp_lg_u32 s64, 0
    s_cbranch_scc1 L_w0_72
    v_mov_b32 v23, s14
    buffer_load_dword v22, v23, s[52:55], 0 offen sc1
L_w0_72:
    s_waitcnt vmcnt(6) lgkmcnt(2)
    v_mfma_f32_32x32x16_bf16 v[96:111], v[56:59], v[228:231], v[96:111]
    v_subrev_u32 v140, 0x1a000, v140
    v_subrev_u32 v141, 0x1a000, v141
    ds_read_b64_tr_b16 v[48:49], v140
    ds_read_b64_tr_b16 v[50:51], v140 offset:1024
    s_add_u32 s99, s99, 0x3800
    s_add_u32 m0, s67, 0x2000
    s_nop 0
    buffer_load_dwordx4 v7, s[44:47], s99 offen lds
    s_waitcnt lgkmcnt(2)
    v_mfma_f32_32x32x16_bf16 v[112:127], v[60:63], v[228:231], v[112:127]
    ds_read_b64_tr_b16 v[52:53], v141
    ds_read_b64_tr_b16 v[54:55], v141 offset:1024
    buffer_load_dwordx4 v[220:223], v15, s[52:55], s1 offen offset:1024 sc1
    s_waitcnt vmcnt(7) lgkmcnt(2)
    v_mfma_f32_32x32x16_bf16 v[96:111], v[48:51], v[232:235], v[96:111]
    s_add_u32 s99, s99, 0x3800
    s_add_u32 m0, s67, 0x4000
    s_nop 0
    buffer_load_dwordx4 v7, s[44:47], s99 offen lds
    s_add_u32 s99, s99, 0x3800
    s_add_u32 m0, s67, 0x10000
    s_nop 0
    buffer_load_dwordx4 v7, s[44:47], s99 offen lds
    s_add_u32 s99, s99, 0x3800
    s_add_u32 m0, s67, 0x12000
    s_nop 0
    buffer_load_dwordx4 v7, s[44:47], s99 offen lds
    s_add_u32 s99, s99, 0x3800
    s_add_u32 m0, s67, 0x14000
    s_nop 0
    buffer_load_dwordx4 v7, s[44:47], s99 offen lds
    s_cmp_lg_u32 s64, 0
    s_cbranch_scc1 L_w0_73
    s_mov_b32 s80, 100000
    s_waitcnt vmcnt(6)
L_pspin_74:
    v_cmp_le_u32 vcc, 16, v22
    s_nop 0
    s_cmp_eq_u64 vcc, -1
    s_nop 2
    s_cbranch_scc1 L_w0_73
    buffer_load_dword v22, v23, s[52:55], 0 offen sc1
    s_sub_u32 s80, s80, 1
    s_waitcnt vmcnt(0)
    s_cmp_lg_u32 s80, 0
    s_cbranch_scc1 L_pspin_74
L_w0_73:
    s_waitcnt lgkmcnt(0)
    s_barrier
    ds_read_b64_tr_b16 v[56:57], v140 offset:8192
    ds_read_b64_tr_b16 v[58:59], v140 offset:9216
    v_mfma_f32_32x32x16_bf16 v[112:127], v[52:55], v[232:235], v[112:127]
    ds_read_b64_tr_b16 v[60:61], v141 offset:8192
    ds_read_b64_tr_b16 v[62:63], v141 offset:9216
    s_mov_b32 s89, s91
    s_lshl_b32 s1, s0, 9
    s_add_u32 s1, s1, s89
    s_add_u32 s3, s89, 7168
    buffer_load_dwordx4 v[224:227], v15, s[52:55], s1 offen sc1
    s_waitcnt vmcnt(11) lgkmcnt(2)
    v_mfma_f32_32x32x16_bf16 v[96:111], v[56:59], v[236:239], v[96:111]
    ds_read_b64_tr_b16 v[48:49], v140 offset:16384
    ds_read_b64_tr_b16 v[50:51], v140 offset:17408
    s_waitcnt lgkmcnt(2)
    v_mfma_f32_32x32x16_bf16 v[112:127], v[60:63], v[236:239], v[112:127]
    ds_read_b64_tr_b16 v[52:53], v141 offset:16384
    ds_read_b64_tr_b16 v[54:55], v141 offset:17408
    buffer_load_dwordx4 v[228:231], v15, s[52:55], s1 offen offset:1024 sc1
    s_waitcnt vmcnt(11) lgkmcnt(2)
    v_mfma_f32_32x32x16_bf16 v[96:111], v[48:51], v[208:211], v[96:111]
    ds_read_b64_tr_b16 v[56:57], v140 offset:24576
    ds_read_b64_tr_b16 v[58:59], v140 offset:25600
    s_waitcnt lgkmcnt(2)
    v_mfma_f32_32x32x16_bf16 v[112:127], v[52:55], v[208:211], v[112:127]
    ds_read_b64_tr_b16 v[60:61], v141 offset:24576
    ds_read_b64_tr_b16 v[62:63], v141 offset:25600
    buffer_load_dwordx4 v[232:235], v15, s[52:55], s1 offen offset:2048 sc1
    s_waitcnt vmcnt(11) lgkmcnt(2)
    v_mfma_f32_32x32x16_bf16 v[96:111], v[56:59], v[212:215], v[96:111]
    v_add_u32 v140, 0x10400, v140
    v_add_u32 v141, 0x10400, v141
    ds_read_b64_tr_b16 v[48:49], v140
    ds_read_b64_tr_b16 v[50:51], v140 offset:1024
    s_waitcnt lgkmcnt(2)
    v_mfma_f32_32x32x16_bf16 v[112:127], v[60:63], v[212:215], v[112:127]
    ds_read_b64_tr_b16 v[52:53], v141
    ds_read_b64_tr_b16 v[54:55], v141 offset:1024
    buffer_load_dwordx4 v[236:239], v15, s[52:55], s1 offen offset:3072 sc1
    s_waitcnt vmcnt(10) lgkmcnt(2)
    v_mfma_f32_32x32x16_bf16 v[96:111], v[48:51], v[216:219], v[96:111]
    ds_read_b64_tr_b16 v[56:57], v140 offset:8192
    ds_read_b64_tr_b16 v[58:59], v140 offset:9216
    s_waitcnt lgkmcnt(2)
    v_mfma_f32_32x32x16_bf16 v[112:127], v[52:55], v[216:219], v[112:127]
    ds_read_b64_tr_b16 v[60:61], v141 offset:8192
    ds_read_b64_tr_b16 v[62:63], v141 offset:9216
    s_add_u32 s1, s1, 4096
    buffer_load_dwordx4 v[208:211], v15, s[52:55], s1 offen sc1
    s_waitcnt vmcnt(9) lgkmcnt(2)
    v_mfma_f32_32x32x16_bf16 v[96:111], v[56:59], v[220:223], v[96:111]
    s_waitcnt vmcnt(8) lgkmcnt(0)
    s_barrier
    v_subrev_u32 v140, 0x8400, v140
    v_subrev_u32 v141, 0x8400, v141
    ds_read_b64_tr_b16 v[48:49], v140
    ds_read_b64_tr_b16 v[50:51], v140 offset:1024
    v_mfma_f32_32x32x16_bf16 v[112:127], v[60:63], v[220:223], v[112:127]
    ds_read_b64_tr_b16 v[52:53], v141
    ds_read_b64_tr_b16 v[54:55], v141 offset:1024
    buffer_load_dwordx4 v[212:215], v15, s[52:55], s1 offen offset:1024 sc1
    s_waitcnt vmcnt(5) lgkmcnt(2)
    v_mfma_f32_32x32x16_bf16 v[64:79], v[48:51], v[224:227], 0
    v_subrev_u32 v140, 0xe000, v140
    v_subrev_u32 v141, 0xe000, v141
    ds_read_b64_tr_b16 v[56:57], v140
    ds_read_b64_tr_b16 v[58:59], v140 offset:1024
    s_waitcnt lgkmcnt(2)
    v_mfma_f32_32x32x16_bf16 v[80:95], v[52:55], v[224:227], 0
    ds_read_b64_tr_b16 v[60:61], v141
    ds_read_b64_tr_b16 v[62:63], v141 offset:1024
    buffer_load_dwordx4 v[216:219], v15, s[52:55], s1 offen offset:2048 sc1
    v_add_u32 v142, 0x16400, v142
    ds_write_b128 v142, v[96:99]
    ds_write_b128 v142, v[100:103] offset:1024
    s_waitcnt vmcnt(5) lgkmcnt(4)
    v_mfma_f32_32x32x16_bf16 v[64:79], v[56:59], v[228:231], v[64:79]
    ds_read_b64_tr_b16 v[48:49], v140 offset:8192
    ds_read_b64_tr_b16 v[50:51], v140 offset:9216
    ds_write_b128 v142, v[104:107] offset:2048
    ds_write_b128 v142, v[108:111] offset:3072
    s_waitcnt lgkmcnt(6)
    v_mfma_f32_32x32x16_bf16 v[80:95], v[60:63], v[228:231], v[80:95]
    ds_read_b64_tr_b16 v[52:53], v141 offset:8192
    ds_read_b64_tr_b16 v[54:55], v141 offset:9216
    ds_write_b128 v142, v[112:115] offset:4096
    ds_write_b128 v142, v[116:119] offset:5120
    s_waitcnt vmcnt(4) lgkmcnt(6)
    v_mfma_f32_32x32x16_bf16 v[64:79], v[48:51], v[232:235], v[64:79]
    ds_read_b64_tr_b16 v[56:57], v140 offset:16384
    ds_read_b64_tr_b16 v[58:59], v140 offset:17408
    ds_write_b128 v142, v[120:123] offset:6144
    ds_write_b128 v142, v[124:127] offset:7168
    s_waitcnt lgkmcnt(6)
    v_mfma_f32_32x32x16_bf16 v[80:95], v[52:55], v[232:235], v[80:95]
    ds_read_b64_tr_b16 v[60:61], v141 offset:16384
    ds_read_b64_tr_b16 v[62:63], v141 offset:17408
    s_waitcnt vmcnt(3) lgkmcnt(4)
    v_mfma_f32_32x32x16_bf16 v[64:79], v[56:59], v[236:239], v[64:79]
    s_waitcnt lgkmcnt(0)
    s_barrier
    v_add_u32 v140, 0x10000, v140
    v_add_u32 v141, 0x10000, v141
    ds_read_b64_tr_b16 v[48:49], v140
    ds_read_b64_tr_b16 v[50:51], v140 offset:1024
    v_mfma_f32_32x32x16_bf16 v[80:95], v[60:63], v[236:239], v[80:95]
    ds_read_b64_tr_b16 v[52:53], v141
    ds_read_b64_tr_b16 v[54:55], v141 offset:1024
    v_add_u32 v143, 0x16400, v143
    ds_read_b128 v[144:147], v143
    ds_read_b128 v[148:151], v143 offset:1024
    ds_read_b128 v[152:155], v143 offset:8192
    ds_read_b128 v[156:159], v143 offset:9216
    ds_read_b128 v[160:163], v143 offset:16384
    ds_read_b128 v[164:167], v143 offset:17408
    ds_read_b128 v[168:171], v143 offset:24576
    ds_read_b128 v[172:175], v143 offset:25600
    s_waitcnt vmcnt(2) lgkmcnt(10)
    v_mfma_f32_32x32x16_bf16 v[64:79], v[48:51], v[208:211], v[64:79]
    ds_read_b64_tr_b16 v[56:57], v140 offset:8192
    ds_read_b64_tr_b16 v[58:59], v140 offset:9216
    v_lshlrev_b32 v24, 16, v36
    v_and_b32 v25, 0xffff0000, v36
    v_lshlrev_b32 v26, 16, v37
    v_and_b32 v27, 0xffff0000, v37
    v_lshlrev_b32 v28, 16, v38
    v_and_b32 v29, 0xffff0000, v38
    v_lshlrev_b32 v30, 16, v39
    v_and_b32 v31, 0xffff0000, v39
    s_waitcnt lgkmcnt(10)
    v_mfma_f32_32x32x16_bf16 v[80:95], v[52:55], v[208:211], v[80:95]
    ds_read_b64_tr_b16 v[60:61], v141 offset:8192
    ds_read_b64_tr_b16 v[62:63], v141 offset:9216
    s_waitcnt lgkmcnt(4)
    v_add_f32 v144, v144, v152
    v_add_f32 v145, v145, v153
    v_add_f32 v146, v146, v154
    v_add_f32 v147, v147, v155
    v_add_f32 v148, v148, v156
    v_add_f32 v149, v149, v157
    v_add_f32 v150, v150, v158
    v_add_f32 v151, v151, v159
    s_waitcnt vmcnt(1) lgkmcnt(2)
    v_mfma_f32_32x32x16_bf16 v[64:79], v[56:59], v[212:215], v[64:79]
    ds_read_b64_tr_b16 v[48:49], v140 offset:16384
    ds_read_b64_tr_b16 v[50:51], v140 offset:17408
    v_add_f32 v160, v160, v168
    v_add_f32 v161, v161, v169
    v_add_f32 v162, v162, v170
    v_add_f32 v163, v163, v171
    v_add_f32 v164, v164, v172
    v_add_f32 v165, v165, v173
    v_add_f32 v166, v166, v174
    v_add_f32 v167, v167, v175
    v_add_f32 v144, v144, v160
    s_waitcnt lgkmcnt(2)
    v_mfma_f32_32x32x16_bf16 v[80:95], v[60:63], v[212:215], v[80:95]
    ds_read_b64_tr_b16 v[52:53], v141 offset:16384
    ds_read_b64_tr_b16 v[54:55], v141 offset:17408
    v_add_f32 v145, v145, v161
    v_add_f32 v146, v146, v162
    v_add_f32 v147, v147, v163
    v_add_f32 v148, v148, v164
    v_add_f32 v149, v149, v165
    v_add_f32 v150, v150, v166
    v_add_f32 v151, v151, v167
    v_mul_f32 v152, 0xbfb8aa3b, v144
    v_mul_f32 v153, 0xbfb8aa3b, v145
    s_waitcnt vmcnt(0) lgkmcnt(2)
    v_mfma_f32_32x32x16_bf16 v[64:79], v[48:51], v[216:219], v[64:79]
    v_mul_f32 v154, 0xbfb8aa3b, v146
    v_mul_f32 v155, 0xbfb8aa3b, v147
    v_mul_f32 v156, 0xbfb8aa3b, v148
    v_mul_f32 v157, 0xbfb8aa3b, v149
    v_mul_f32 v158, 0xbfb8aa3b, v150
    v_mul_f32 v159, 0xbfb8aa3b, v151
    v_exp_f32 v152, v152
    v_exp_f32 v153, v153
    v_exp_f32 v154, v154
    s_waitcnt lgkmcnt(0)
    v_mfma_f32_32x32x16_bf16 v[80:95], v[52:55], v[216:219], v[80:95]
    v_exp_f32 v155, v155
    v_exp_f32 v156, v156
    v_exp_f32 v157, v157
    v_exp_f32 v158, v158
    v_exp_f32 v159, v159
    v_add_f32 v152, 1.0, v152
    v_add_f32 v153, 1.0, v153
    v_add_f32 v154, 1.0, v154
    v_add_f32 v155, 1.0, v155
    v_subrev_u32 v142, 0x16400, v142
    ds_write_b128 v142, v[64:67]
    ds_write_b128 v142, v[68:71] offset:1024
    ds_write_b128 v142, v[72:75] offset:2048
    ds_write_b128 v142, v[76:79] offset:3072
    ds_write_b128 v142, v[80:83] offset:4096
    ds_write_b128 v142, v[84:87] offset:5120
    ds_write_b128 v142, v[88:91] offset:6144
    ds_write_b128 v142, v[92:95] offset:7168
    v_add_f32 v156, 1.0, v156
    v_add_f32 v157, 1.0, v157
    v_add_f32 v158, 1.0, v158
    v_add_f32 v159, 1.0, v159
    v_rcp_f32 v152, v152
    v_rcp_f32 v153, v153
    v_rcp_f32 v154, v154
    v_rcp_f32 v155, v155
    v_rcp_f32 v156, v156
    v_rcp_f32 v157, v157
    v_rcp_f32 v158, v158
    v_rcp_f32 v159, v159
    v_mul_f32 v152, v152, v144
    v_mul_f32 v153, v153, v145
    v_mul_f32 v154, v154, v146
    v_mul_f32 v155, v155, v147
    v_mul_f32 v156, v156, v148
    v_mul_f32 v157, v157, v149
    v_mul_f32 v158, v158, v150
    v_mul_f32 v159, v159, v151
    s_waitcnt lgkmcnt(0)
    s_barrier
    v_subrev_u32 v143, 0x16400, v143
    ds_read_b128 v[96:99], v143
    ds_read_b128 v[100:103], v143 offset:1024
    ds_read_b128 v[104:107], v143 offset:8192
    ds_read_b128 v[108:111], v143 offset:9216
    ds_read_b128 v[112:115], v143 offset:16384
    ds_read_b128 v[116:119], v143 offset:17408
    ds_read_b128 v[120:123], v143 offset:24576
    ds_read_b128 v[124:127], v143 offset:25600
    s_waitcnt lgkmcnt(4)
    v_pk_add_f32 v[96:97], v[96:97], v[104:105]
    v_pk_add_f32 v[98:99], v[98:99], v[106:107]
    v_pk_add_f32 v[100:101], v[100:101], v[108:109]
    v_pk_add_f32 v[102:103], v[102:103], v[110:111]
    s_waitcnt lgkmcnt(0)
    v_pk_add_f32 v[112:113], v[112:113], v[120:121]
    v_pk_add_f32 v[114:115], v[114:115], v[122:123]
    v_pk_add_f32 v[116:117], v[116:117], v[124:125]
    v_pk_add_f32 v[118:119], v[118:119], v[126:127]
    v_pk_add_f32 v[96:97], v[96:97], v[112:113]
    v_pk_add_f32 v[98:99], v[98:99], v[114:115]
    v_pk_add_f32 v[100:101], v[100:101], v[116:117]
    v_pk_add_f32 v[102:103], v[102:103], v[118:119]
    v_pk_fma_f32 v[24:25], v[96:97], v[152:153], v[24:25]
    v_pk_fma_f32 v[26:27], v[98:99], v[154:155], v[26:27]
    v_pk_fma_f32 v[28:29], v[100:101], v[156:157], v[28:29]
    v_pk_fma_f32 v[30:31], v[102:103], v[158:159], v[30:31]
    v_cvt_pk_bf16_f32 v24, v24, v25
    v_cvt_pk_bf16_f32 v25, v26, v27
    v_cvt_pk_bf16_f32 v26, v28, v29
    v_cvt_pk_bf16_f32 v27, v30, v31
    buffer_store_dwordx2 v[24:25], v4, s[48:51], s69 offen
    buffer_store_dwordx2 v[26:27], v4, s[48:51], s69 offen offset:16
L_end:
    s_endpgm
L_light:
    s_add_u32 m0, s68, 0x0
    s_nop 0
    buffer_load_dwordx4 v2, s[24:27], s69 offen lds
    buffer_load_dwordx4 v3, s[24:27], s69 offen offset:1024 lds
    s_lshl_b32 s81, s64, 12
    s_add_u32 m0, s81, 0x4000
    s_add_u32 s72, s72, 2048
    buffer_load_dwordx4 v6, s[36:39], s72 offen lds
    s_sub_u32 s72, s72, 896
    buffer_load_dwordx4 v6, s[36:39], s72 offen offset:1024 lds
    s_sub_u32 s72, s72, 896
    buffer_load_dwordx4 v6, s[36:39], s72 offen offset:2048 lds
    s_sub_u32 s72, s72, 896
    buffer_load_dwordx4 v6, s[36:39], s72 offen offset:3072 lds
    s_barrier
    s_add_u32 m0, s68, 0xc000
    s_add_u32 s69, s69, 128
    buffer_load_dwordx4 v2, s[24:27], s69 offen lds
    buffer_load_dwordx4 v3, s[24:27], s69 offen offset:1024 lds
    s_lshl_b32 s81, s64, 12
    s_add_u32 m0, s81, 0x10000
    s_add_u32 s72, s72, 0x2aa80
    buffer_load_dwordx4 v6, s[36:39], s72 offen lds
    s_sub_u32 s72, s72, 896
    buffer_load_dwordx4 v6, s[36:39], s72 offen offset:1024 lds
    s_sub_u32 s72, s72, 896
    buffer_load_dwordx4 v6, s[36:39], s72 offen offset:2048 lds
    s_cmp_lg_u32 s64, 2
    s_cbranch_scc1 L_cpf_75
    s_getpc_b64 s[96:97]
L_here_76:
    v_lshlrev_b32 v240, 7, v1
    v_min_u32 v240, L_code_end-L_here_76, v240
    global_load_dword v0, v240, s[96:97]
    v_add_u32 v240, 8192, v240
L_cpf_75:
    s_mov_b32 s56, s20
    s_mov_b32 s57, s21
    s_mov_b32 s58, 0x100
    s_mov_b32 s59, 0x20000
    s_mul_i32 s81, s95, 84
    s_lshl1_add_u32 s81, s87, s81
    s_cmp_eq_u32 s66, 15
    s_cselect_b32 s82, 18, s66
    s_lshl2_add_u32 s92, s82, s81
    s_lshl_b32 s92, s92, 10
    s_add_u32 s92, s92, 0x80000
    s_and_b32 s90, s66, 3
    s_lshl2_add_u32 s90, s65, s90
    v_and_b32 v240, 31, v1
    v_lshrrev_b32 v241, 5, v1
    v_bfe_u32 v242, v1, 1, 3
    v_xor_b32 v242, v242, v241
    v_lshlrev_b32 v242, 4, v242
    v_lshl_or_b32 v8, v240, 7, v242
    s_lshl_b32 s81, s88, 12
    v_add_u32 v8, s81, v8
    v_xor_b32 v9, 32, v8
    v_xor_b32 v10, 64, v8
    v_xor_b32 v11, 96, v8
    v_bfe_u32 v240, v1, 4, 1
    v_bfe_u32 v242, v1, 2, 2
    v_lshlrev_b32 v242, 7, v242
    v_and_b32 v243, 3, v1
    v_lshl_or_b32 v242, v243, 3, v242
    v_bfe_u32 v246, v1, 3, 1
    v_lshlrev_b32 v246, 1, v246
    v_xor_b32 v246, v246, v240
    s_lshl_b32 s81, s87, 1
    v_xor_b32 v246, s81, v246
    v_lshl_or_b32 v242, v246, 5, v242
    v_mul_u32_u24 v246, 4096, v241
    v_add_u32 v14, v242, v246
    v_lshl_add_u32 v12, v240, 10, v14
    v_xor_b32 v13, 32, v12
    v_and_b32 v243, 15, v1
    v_cmp_eq_u32 vcc, v243, v240
    v_mov_b32 v243, 0x3f803f80
    v_mov_b32 v228, 0
    v_mov_b32 v229, 0
    v_mov_b32 v230, 0
    v_mov_b32 v231, 0
    v_add_u32 v232, s68, v15
    s_mov_b32 s11, 0x3f803f80
    v_cndmask_b32 v208, 0, v243, vcc
    v_cndmask_b32 v209, 0, v243, vcc
    v_cndmask_b32 v210, 0, v243, vcc
    v_cndmask_b32 v211, 0, v243, vcc
    s_mul_i32 s81, s87, 2560
    s_add_u32 s81, s81, 0x26400
    v_and_b32 v16, 31, v1
    v_lshl_add_u32 v16, v16, 4, s81
    s_waitcnt vmcnt(5)
    s_barrier
    ds_read_b128 v[128:131], v8
    ds_read_b64_tr_b16 v[176:177], v14 offset:16384
    ds_read_b64_tr_b16 v[178:179], v14 offset:16896
    ds_read_b64_tr_b16 v[180:181], v14 offset:17408
    ds_read_b64_tr_b16 v[182:183], v14 offset:17920
    ds_read_b64_tr_b16 v[184:185], v14 offset:18432
    ds_read_b64_tr_b16 v[186:187], v14 offset:18944
    ds_read_b64_tr_b16 v[188:189], v14 offset:19456
    ds_read_b64_tr_b16 v[190:191], v14 offset:19968
    s_waitcnt lgkmcnt(6)
    v_mfma_f32_32x32x16_bf16 v[48:63], v[176:179], v[128:131], 0
    ds_read_b128 v[132:135], v9
    ds_read_b64_tr_b16 v[192:193], v14 offset:24576
    ds_read_b64_tr_b16 v[194:195], v14 offset:25088
    s_sub_u32 s72, s72, 896
    buffer_load_dwordx4 v6, s[36:39], s72 offen offset:3072 lds
    ds_read_b128 v[240:243], v232
    ds_read_b128 v[244:247], v232 offset:1024
    s_waitcnt lgkmcnt(9)
    v_mfma_f32_32x32x16_bf16 v[64:79], v[180:183], v[128:131], 0
    ds_read_b64_tr_b16 v[196:197], v14 offset:25600
    ds_read_b64_tr_b16 v[198:199], v14 offset:26112
    s_add_u32 m0, s68, 0x18000
    s_add_u32 s69, s69, 128
    buffer_load_dwordx4 v2, s[24:27], s69 offen lds
    s_waitcnt lgkmcnt(2)
    v_dot2c_f32_bf16 v228, s11, v240
    v_dot2c_f32_bf16 v229, v240, v240
    v_dot2c_f32_bf16 v230, s11, v244
    v_dot2c_f32_bf16 v231, v244, v244
    v_dot2c_f32_bf16 v228, s11, v241
    v_dot2c_f32_bf16 v229, v241, v241
    v_dot2c_f32_bf16 v230, s11, v245
    v_dot2c_f32_bf16 v231, v245, v245
    v_dot2c_f32_bf16 v228, s11, v242
    v_dot2c_f32_bf16 v229, v242, v242
    v_dot2c_f32_bf16 v230, s11, v246
    v_dot2c_f32_bf16 v231, v246, v246
    v_dot2c_f32_bf16 v228, s11, v243
    v_dot2c_f32_bf16 v229, v243, v243
    v_dot2c_f32_bf16 v230, s11, v247
    v_dot2c_f32_bf16 v231, v247, v247
    v_mfma_f32_32x32x16_bf16 v[80:95], v[184:187], v[128:131], 0
    ds_read_b64_tr_b16 v[200:201], v14 offset:26624
    ds_read_b64_tr_b16 v[202:203], v14 offset:27136
    v_mfma_f32_32x32x16_bf16 v[96:111], v[188:191], v[128:131], 0
    ds_read_b64_tr_b16 v[204:205], v14 offset:27648
    ds_read_b64_tr_b16 v[206:207], v14 offset:28160
    buffer_load_dwordx4 v3, s[24:27], s69 offen offset:1024 lds
    s_cmp_lg_u32 s88, 0
    s_cbranch_scc1 L_cs_77
    v_mfma_f32_16x16x32_bf16 v[212:215], v[208:211], v[176:179], 0
    v_mfma_f32_16x16x32_bf16 v[216:219], v[208:211], v[180:183], 0
    v_mfma_f32_16x16x32_bf16 v[220:223], v[208:211], v[184:187], 0
    v_mfma_f32_16x16x32_bf16 v[224:227], v[208:211], v[188:191], 0
L_cs_77:
    v_mfma_f32_32x32x16_bf16 v[48:63], v[192:195], v[132:135], v[48:63]
    ds_read_b128 v[136:139], v10
    ds_read_b64_tr_b16 v[176:177], v14 offset:32768
    ds_read_b64_tr_b16 v[178:179], v14 offset:33280
    s_waitcnt lgkmcnt(7)
    v_mfma_f32_32x32x16_bf16 v[64:79], v[196:199], v[132:135], v[64:79]
    ds_read_b64_tr_b16 v[180:181], v14 offset:33792
    ds_read_b64_tr_b16 v[182:183], v14 offset:34304
    s_lshl_b32 s81, s64, 12
    s_add_u32 m0, s81, 0x1c000
    s_add_u32 s72, s72, 0x2aa80
    buffer_load_dwordx4 v6, s[36:39], s72 offen lds
    s_waitcnt lgkmcnt(7)
    v_mfma_f32_32x32x16_bf16 v[80:95], v[200:203], v[132:135], v[80:95]
    ds_read_b64_tr_b16 v[184:185], v14 offset:34816
    ds_read_b64_tr_b16 v[186:187], v14 offset:35328
    s_waitcnt lgkmcnt(7)
    v_mfma_f32_32x32x16_bf16 v[96:111], v[204:207], v[132:135], v[96:111]
    ds_read_b64_tr_b16 v[188:189], v14 offset:35840
    ds_read_b64_tr_b16 v[190:191], v14 offset:36352
    s_sub_u32 s72, s72, 896
    buffer_load_dwordx4 v6, s[36:39], s72 offen offset:1024 lds
    s_cmp_lg_u32 s88, 1
    s_cbranch_scc1 L_cs_78
    v_mfma_f32_16x16x32_bf16 v[212:215], v[208:211], v[192:195], 0
    v_mfma_f32_16x16x32_bf16 v[216:219], v[208:211], v[196:199], 0
    v_mfma_f32_16x16x32_bf16 v[220:223], v[208:211], v[200:203], 0
    v_mfma_f32_16x16x32_bf16 v[224:227], v[208:211], v[204:207], 0
L_cs_78:
    s_waitcnt lgkmcnt(6)
    v_mfma_f32_32x32x16_bf16 v[48:63], v[176:179], v[136:139], v[48:63]
    ds_read_b128 v[140:143], v11
    ds_read_b64_tr_b16 v[192:193], v14 offset:40960
    ds_read_b64_tr_b16 v[194:195], v14 offset:41472
    s_waitcnt lgkmcnt(7)
    v_mfma_f32_32x32x16_bf16 v[64:79], v[180:183], v[136:139], v[64:79]
    ds_read_b64_tr_b16 v[196:197], v14 offset:41984
    ds_read_b64_tr_b16 v[198:199], v14 offset:42496
    s_sub_u32 s72, s72, 896
    buffer_load_dwordx4 v6, s[36:39], s72 offen offset:2048 lds
    s_waitcnt lgkmcnt(7)
    v_mfma_f32_32x32x16_bf16 v[80:95], v[184:187], v[136:139], v[80:95]
    ds_read_b64_tr_b16 v[200:201], v14 offset:43008
    ds_read_b64_tr_b16 v[202:203], v14 offset:43520
    s_waitcnt lgkmcnt(7)
    v_mfma_f32_32x32x16_bf16 v[96:111], v[188:191], v[136:139], v[96:111]
    ds_read_b64_tr_b16 v[204:205], v14 offset:44032
    ds_read_b64_tr_b16 v[206:207], v14 offset:44544
    s_sub_u32 s72, s72, 896
    buffer_load_dwordx4 v6, s[36:39], s72 offen offset:3072 lds
    s_cmp_lg_u32 s88, 2
    s_cbranch_scc1 L_cs_79
    v_mfma_f32_16x16x32_bf16 v[212:215], v[208:211], v[176:179], 0
    v_mfma_f32_16x16x32_bf16 v[216:219], v[208:211], v[180:183], 0
    v_mfma_f32_16x16x32_bf16 v[220:223], v[208:211], v[184:187], 0
    v_mfma_f32_16x16x32_bf16 v[224:227], v[208:211], v[188:191], 0
L_cs_79:
    s_waitcnt lgkmcnt(6)
    v_mfma_f32_32x32x16_bf16 v[48:63], v[192:195], v[140:143], v[48:63]
    s_waitcnt vmcnt(6) lgkmcnt(0)
    s_barrier
    v_add_u32 v8, 0xc000, v8
    v_add_u32 v9, 0xc000, v9
    v_add_u32 v10, 0xc000, v10
    v_add_u32 v11, 0xc000, v11
    ds_read_b128 v[128:131], v8
    v_add_u32 v14, 0x10000, v14
    ds_read_b64_tr_b16 v[176:177], v14
    ds_read_b64_tr_b16 v[178:179], v14 offset:512
    v_mfma_f32_32x32x16_bf16 v[64:79], v[196:199], v[140:143], v[64:79]
    ds_read_b64_tr_b16 v[180:181], v14 offset:1024
    ds_read_b64_tr_b16 v[182:183], v14 offset:1536
    s_add_u32 m0, s68, 0x0
    s_add_u32 s69, s69, 128
    buffer_load_dwordx4 v2, s[24:27], s69 offen lds
    v_mfma_f32_32x32x16_bf16 v[80:95], v[200:203], v[140:143], v[80:95]
    ds_read_b64_tr_b16 v[184:185], v14 offset:2048
    ds_read_b64_tr_b16 v[186:187], v14 offset:2560
    v_mfma_f32_32x32x16_bf16 v[96:111], v[204:207], v[140:143], v[96:111]
    ds_read_b64_tr_b16 v[188:189], v14 offset:3072
    ds_read_b64_tr_b16 v[190:191], v14 offset:3584
    buffer_load_dwordx4 v3, s[24:27], s69 offen offset:1024 lds
    s_cmp_lg_u32 s88, 3
    s_cbranch_scc1 L_cs_80
    v_mfma_f32_16x16x32_bf16 v[212:215], v[208:211], v[192:195], 0
    v_mfma_f32_16x16x32_bf16 v[216:219], v[208:211], v[196:199], 0
    v_mfma_f32_16x16x32_bf16 v[220:223], v[208:211], v[200:203], 0
    v_mfma_f32_16x16x32_bf16 v[224:227], v[208:211], v[204:207], 0
L_cs_80:
    s_waitcnt lgkmcnt(6)
    v_mfma_f32_32x32x16_bf16 v[48:63], v[176:179], v[128:131], v[48:63]
    ds_read_b128 v[132:135], v9
    ds_read_b64_tr_b16 v[192:193], v14 offset:8192
    ds_read_b64_tr_b16 v[194:195], v14 offset:8704
    v_add_u32 v232, 0xc000, v232
    ds_read_b128 v[240:243], v232
    ds_read_b128 v[244:247], v232 offset:1024
    s_waitcnt lgkmcnt(9)
    v_mfma_f32_32x32x16_bf16 v[64:79], v[180:183], v[128:131], v[64:79]
    ds_read_b64_tr_b16 v[196:197], v14 offset:9216
    ds_read_b64_tr_b16 v[198:199], v14 offset:9728
    s_lshl_b32 s81, s64, 12
    s_add_u32 m0, s81, 0x4000
    s_add_u32 s72, s72, 0x2aa80
    buffer_load_dwordx4 v6, s[36:39], s72 offen lds
    s_waitcnt lgkmcnt(2)
    v_dot2c_f32_bf16 v228, s11, v240
    v_dot2c_f32_bf16 v229, v240, v240
    v_dot2c_f32_bf16 v230, s11, v244
    v_dot2c_f32_bf16 v231, v244, v244
    v_dot2c_f32_bf16 v228, s11, v241
    v_dot2c_f32_bf16 v229, v241, v241
    v_dot2c_f32_bf16 v230, s11, v245
    v_dot2c_f32_bf16 v231, v245, v245
    v_dot2c_f32_bf16 v228, s11, v242
    v_dot2c_f32_bf16 v229, v242, v242
    v_dot2c_f32_bf16 v230, s11, v246
    v_dot2c_f32_bf16 v231, v246, v246
    v_dot2c_f32_bf16 v228, s11, v243
    v_dot2c_f32_bf16 v229, v243, v243
    v_dot2c_f32_bf16 v230, s11, v247
    v_dot2c_f32_bf16 v231, v247, v247
    v_mfma_f32_32x32x16_bf16 v[80:95], v[184:187], v[128:131], v[80:95]
    ds_read_b64_tr_b16 v[200:201], v14 offset:10240
    ds_read_b64_tr_b16 v[202:203], v14 offset:10752
    v_mfma_f32_32x32x16_bf16 v[96:111], v[188:191], v[128:131], v[96:111]
    ds_read_b64_tr_b16 v[204:205], v14 offset:11264
    ds_read_b64_tr_b16 v[206:207], v14 offset:11776
    s_sub_u32 s72, s72, 896
    buffer_load_dwordx4 v6, s[36:39], s72 offen offset:1024 lds
    s_cmp_lg_u32 s88, 0
    s_cbranch_scc1 L_cs_81
    v_mfma_f32_16x16x32_bf16 v[212:215], v[208:211], v[176:179], v[212:215]
    v_mfma_f32_16x16x32_bf16 v[216:219], v[208:211], v[180:183], v[216:219]
    v_mfma_f32_16x16x32_bf16 v[220:223], v[208:211], v[184:187], v[220:223]
    v_mfma_f32_16x16x32_bf16 v[224:227], v[208:211], v[188:191], v[224:227]
L_cs_81:
    v_mfma_f32_32x32x16_bf16 v[48:63], v[192:195], v[132:135], v[48:63]
    ds_read_b128 v[136:139], v10
    ds_read_b64_tr_b16 v[176:177], v14 offset:16384
    ds_read_b64_tr_b16 v[178:179], v14 offset:16896
    s_waitcnt lgkmcnt(7)
    v_mfma_f32_32x32x16_bf16 v[64:79], v[196:199], v[132:135], v[64:79]
    ds_read_b64_tr_b16 v[180:181], v14 offset:17408
    ds_read_b64_tr_b16 v[182:183], v14 offset:17920
    s_sub_u32 s72, s72, 896
    buffer_load_dwordx4 v6, s[36:39], s72 offen offset:2048 lds
    s_waitcnt lgkmcnt(7)
    v_mfma_f32_32x32x16_bf16 v[80:95], v[200:203], v[132:135], v[80:95]
    ds_read_b64_tr_b16 v[184:185], v14 offset:18432
    ds_read_b64_tr_b16 v[186:187], v14 offset:18944
    s_waitcnt lgkmcnt(7)
    v_mfma_f32_32x32x16_bf16 v[96:111], v[204:207], v[132:135], v[96:111]
    ds_read_b64_tr_b16 v[188:189], v14 offset:19456
    ds_read_b64_tr_b16 v[190:191], v14 offset:19968
    s_sub_u32 s72, s72, 896
    buffer_load_dwordx4 v6, s[36:39], s72 offen offset:3072 lds
    s_cmp_lg_u32 s88, 1
    s_cbranch_scc1 L_cs_82
    v_mfma_f32_16x16x32_bf16 v[212:215], v[208:211], v[192:195], v[212:215]
    v_mfma_f32_16x16x32_bf16 v[216:219], v[208:211], v[196:199], v[216:219]
    v_mfma_f32_16x16x32_bf16 v[220:223], v[208:211], v[200:203], v[220:223]
    v_mfma_f32_16x16x32_bf16 v[224:227], v[208:211], v[204:207], v[224:227]
L_cs_82:
    s_waitcnt lgkmcnt(6)
    v_mfma_f32_32x32x16_bf16 v[48:63], v[176:179], v[136:139], v[48:63]
    ds_read_b128 v[140:143], v11
    ds_read_b64_tr_b16 v[192:193], v14 offset:24576
    ds_read_b64_tr_b16 v[194:195], v14 offset:25088
    s_waitcnt lgkmcnt(7)
    v_mfma_f32_32x32x16_bf16 v[64:79], v[180:183], v[136:139], v[64:79]
    ds_read_b64_tr_b16 v[196:197], v14 offset:25600
    ds_read_b64_tr_b16 v[198:199], v14 offset:26112
    s_waitcnt lgkmcnt(7)
    v_mfma_f32_32x32x16_bf16 v[80:95], v[184:187], v[136:139], v[80:95]
    ds_read_b64_tr_b16 v[200:201], v14 offset:26624
    ds_read_b64_tr_b16 v[202:203], v14 offset:27136
    s_waitcnt lgkmcnt(7)
    v_mfma_f32_32x32x16_bf16 v[96:111], v[188:191], v[136:139], v[96:111]
    ds_read_b64_tr_b16 v[204:205], v14 offset:27648
    ds_read_b64_tr_b16 v[206:207], v14 offset:28160
    s_cmp_lg_u32 s88, 2
    s_cbranch_scc1 L_cs_83
    v_mfma_f32_16x16x32_bf16 v[212:215], v[208:211], v[176:179], v[212:215]
    v_mfma_f32_16x16x32_bf16 v[216:219], v[208:211], v[180:183], v[216:219]
    v_mfma_f32_16x16x32_bf16 v[220:223], v[208:211], v[184:187], v[220:223]
    v_mfma_f32_16x16x32_bf16 v[224:227], v[208:211], v[188:191], v[224:227]
L_cs_83:
    s_waitcnt lgkmcnt(6)
    v_mfma_f32_32x32x16_bf16 v[48:63], v[192:195], v[140:143], v[48:63]
    s_waitcnt vmcnt(6) lgkmcnt(0)
    s_barrier
    v_add_u32 v8, 0xc000, v8
    v_add_u32 v9, 0xc000, v9
    v_add_u32 v10, 0xc000, v10
    v_add_u32 v11, 0xc000, v11
    ds_read_b128 v[128:131], v8
    v_add_u32 v14, 0xc000, v14
    ds_read_b64_tr_b16 v[176:177], v14
    ds_read_b64_tr_b16 v[178:179], v14 offset:512
    v_mfma_f32_32x32x16_bf16 v[64:79], v[196:199], v[140:143], v[64:79]
    ds_read_b64_tr_b16 v[180:181], v14 offset:1024
    ds_read_b64_tr_b16 v[182:183], v14 offset:1536
    s_add_u32 m0, s68, 0xc000
    s_add_u32 s69, s69, 128
    buffer_load_dwordx4 v2, s[24:27], s69 offen lds
    v_mfma_f32_32x32x16_bf16 v[80:95], v[200:203], v[140:143], v[80:95]
    ds_read_b64_tr_b16 v[184:185], v14 offset:2048
    ds_read_b64_tr_b16 v[186:187], v14 offset:2560
    v_mfma_f32_32x32x16_bf16 v[96:111], v[204:207], v[140:143], v[96:111]
    ds_read_b64_tr_b16 v[188:189], v14 offset:3072
    ds_read_b64_tr_b16 v[190:191], v14 offset:3584
    buffer_load_dwordx4 v3, s[24:27], s69 offen offset:1024 lds
    s_cmp_lg_u32 s88, 3
    s_cbranch_scc1 L_cs_84
    v_mfma_f32_16x16x32_bf16 v[212:215], v[208:211], v[192:195], v[212:215]
    v_mfma_f32_16x16x32_bf16 v[216:219], v[208:211], v[196:199], v[216:219]
    v_mfma_f32_16x16x32_bf16 v[220:223], v[208:211], v[200:203], v[220:223]
    v_mfma_f32_16x16x32_bf16 v[224:227], v[208:211], v[204:207], v[224:227]
L_cs_84:
    s_waitcnt lgkmcnt(6)
    v_mfma_f32_32x32x16_bf16 v[48:63], v[176:179], v[128:131], v[48:63]
    ds_read_b128 v[132:135], v9
    ds_read_b64_tr_b16 v[192:193], v14 offset:8192
    ds_read_b64_tr_b16 v[194:195], v14 offset:8704
    v_add_u32 v232, 0xc000, v232
    ds_read_b128 v[240:243], v232
    ds_read_b128 v[244:247], v232 offset:1024
    s_waitcnt lgkmcnt(9)
    v_mfma_f32_32x32x16_bf16 v[64:79], v[180:183], v[128:131], v[64:79]
    ds_read_b64_tr_b16 v[196:197], v14 offset:9216
    ds_read_b64_tr_b16 v[198:199], v14 offset:9728
    s_lshl_b32 s81, s64, 12
    s_add_u32 m0, s81, 0x10000
    s_add_u32 s72, s72, 0x2aa80
    buffer_load_dwordx4 v6, s[36:39], s72 offen lds
    s_waitcnt lgkmcnt(2)
    v_dot2c_f32_bf16 v228, s11, v240
    v_dot2c_f32_bf16 v229, v240, v240
    v_dot2c_f32_bf16 v230, s11, v244
    v_dot2c_f32_bf16 v231, v244, v244
    v_dot2c_f32_bf16 v228, s11, v241
    v_dot2c_f32_bf16 v229, v241, v241
    v_dot2c_f32_bf16 v230, s11, v245
    v_dot2c_f32_bf16 v231, v245, v245
    v_dot2c_f32_bf16 v228, s11, v242
    v_dot2c_f32_bf16 v229, v242, v242
    v_dot2c_f32_bf16 v230, s11, v246
    v_dot2c_f32_bf16 v231, v246, v246
    v_dot2c_f32_bf16 v228, s11, v243
    v_dot2c_f32_bf16 v229, v243, v243
    v_dot2c_f32_bf16 v230, s11, v247
    v_dot2c_f32_bf16 v231, v247, v247
    v_mfma_f32_32x32x16_bf16 v[80:95], v[184:187], v[128:131], v[80:95]
    ds_read_b64_tr_b16 v[200:201], v14 offset:10240
    ds_read_b64_tr_b16 v[202:203], v14 offset:10752
    v_mfma_f32_32x32x16_bf16 v[96:111], v[188:191], v[128:131], v[96:111]
    ds_read_b64_tr_b16 v[204:205], v14 offset:11264
    ds_read_b64_tr_b16 v[206:207], v14 offset:11776
    s_sub_u32 s72, s72, 896
    buffer_load_dwordx4 v6, s[36:39], s72 offen offset:1024 lds
    s_cmp_lg_u32 s88, 0
    s_cbranch_scc1 L_cs_85
    v_mfma_f32_16x16x32_bf16 v[212:215], v[208:211], v[176:179], v[212:215]
    v_mfma_f32_16x16x32_bf16 v[216:219], v[208:211], v[180:183], v[216:219]
    v_mfma_f32_16x16x32_bf16 v[220:223], v[208:211], v[184:187], v[220:223]
    v_mfma_f32_16x16x32_bf16 v[224:227], v[208:211], v[188:191], v[224:227]
L_cs_85:
    v_mfma_f32_32x32x16_bf16 v[48:63], v[192:195], v[132:135], v[48:63]
    ds_read_b128 v[136:139], v10
    ds_read_b64_tr_b16 v[176:177], v14 offset:16384
    ds_read_b64_tr_b16 v[178:179], v14 offset:16896
    s_waitcnt lgkmcnt(7)
    v_mfma_f32_32x32x16_bf16 v[64:79], v[196:199], v[132:135], v[64:79]
    ds_read_b64_tr_b16 v[180:181], v14 offset:17408
    ds_read_b64_tr_b16 v[182:183], v14 offset:17920
    s_sub_u32 s72, s72, 896
    buffer_load_dwordx4 v6, s[36:39], s72 offen offset:2048 lds
    s_waitcnt lgkmcnt(7)
    v_mfma_f32_32x32x16_bf16 v[80:95], v[200:203], v[132:135], v[80:95]
    ds_read_b64_tr_b16 v[184:185], v14 offset:18432
    ds_read_b64_tr_b16 v[186:187], v14 offset:18944
    s_waitcnt lgkmcnt(7)
    v_mfma_f32_32x32x16_bf16 v[96:111], v[204:207], v[132:135], v[96:111]
    ds_read_b64_tr_b16 v[188:189], v14 offset:19456
    ds_read_b64_tr_b16 v[190:191], v14 offset:19968
    s_sub_u32 s72, s72, 896
    buffer_load_dwordx4 v6, s[36:39], s72 offen offset:3072 lds
    s_cmp_lg_u32 s88, 1
    s_cbranch_scc1 L_cs_86
    v_mfma_f32_16x16x32_bf16 v[212:215], v[208:211], v[192:195], v[212:215]
    v_mfma_f32_16x16x32_bf16 v[216:219], v[208:211], v[196:199], v[216:219]
    v_mfma_f32_16x16x32_bf16 v[220:223], v[208:211], v[200:203], v[220:223]
    v_mfma_f32_16x16x32_bf16 v[224:227], v[208:211], v[204:207], v[224:227]
L_cs_86:
    s_waitcnt lgkmcnt(6)
    v_mfma_f32_32x32x16_bf16 v[48:63], v[176:179], v[136:139], v[48:63]
    ds_read_b128 v[140:143], v11
    ds_read_b64_tr_b16 v[192:193], v14 offset:24576
    ds_read_b64_tr_b16 v[194:195], v14 offset:25088
    s_waitcnt lgkmcnt(7)
    v_mfma_f32_32x32x16_bf16 v[64:79], v[180:183], v[136:139], v[64:79]
    ds_read_b64_tr_b16 v[196:197], v14 offset:25600
    ds_read_b64_tr_b16 v[198:199], v14 offset:26112
    s_waitcnt lgkmcnt(7)
    v_mfma_f32_32x32x16_bf16 v[80:95], v[184:187], v[136:139], v[80:95]
    ds_read_b64_tr_b16 v[200:201], v14 offset:26624
    ds_read_b64_tr_b16 v[202:203], v14 offset:27136
    s_waitcnt lgkmcnt(7)
    v_mfma_f32_32x32x16_bf16 v[96:111], v[188:191], v[136:139], v[96:111]
    ds_read_b64_tr_b16 v[204:205], v14 offset:27648
    ds_read_b64_tr_b16 v[206:207], v14 offset:28160
    s_cmp_lg_u32 s88, 2
    s_cbranch_scc1 L_cs_87
    v_mfma_f32_16x16x32_bf16 v[212:215], v[208:211], v[176:179], v[212:215]
    v_mfma_f32_16x16x32_bf16 v[216:219], v[208:211], v[180:183], v[216:219]
    v_mfma_f32_16x16x32_bf16 v[220:223], v[208:211], v[184:187], v[220:223]
    v_mfma_f32_16x16x32_bf16 v[224:227], v[208:211], v[188:191], v[224:227]
L_cs_87:
    s_waitcnt lgkmcnt(6)
    v_mfma_f32_32x32x16_bf16 v[48:63], v[192:195], v[140:143], v[48:63]
    s_waitcnt vmcnt(6) lgkmcnt(0)
    s_barrier
    v_subrev_u32 v8, 0x18000, v8
    v_subrev_u32 v9, 0x18000, v9
    v_subrev_u32 v10, 0x18000, v10
    v_subrev_u32 v11, 0x18000, v11
    ds_read_b128 v[128:131], v8
    v_subrev_u32 v14, 0x18000, v14
    ds_read_b64_tr_b16 v[176:177], v14
    ds_read_b64_tr_b16 v[178:179], v14 offset:512
    v_mfma_f32_32x32x16_bf16 v[64:79], v[196:199], v[140:143], v[64:79]
    ds_read_b64_tr_b16 v[180:181], v14 offset:1024
    ds_read_b64_tr_b16 v[182:183], v14 offset:1536
    s_add_u32 m0, s68, 0x18000
    s_add_u32 s69, s69, 128
    buffer_load_dwordx4 v2, s[24:27], s69 offen lds
    v_mfma_f32_32x32x16_bf16 v[80:95], v[200:203], v[140:143], v[80:95]
    ds_read_b64_tr_b16 v[184:185], v14 offset:2048
    ds_read_b64_tr_b16 v[186:187], v14 offset:2560
    v_mfma_f32_32x32x16_bf16 v[96:111], v[204:207], v[140:143], v[96:111]
    ds_read_b64_tr_b16 v[188:189], v14 offset:3072
    ds_read_b64_tr_b16 v[190:191], v14 offset:3584
    buffer_load_dwordx4 v3, s[24:27], s69 offen offset:1024 lds
    s_cmp_lg_u32 s88, 3
    s_cbranch_scc1 L_cs_88
    v_mfma_f32_16x16x32_bf16 v[212:215], v[208:211], v[192:195], v[212:215]
    v_mfma_f32_16x16x32_bf16 v[216:219], v[208:211], v[196:199], v[216:219]
    v_mfma_f32_16x16x32_bf16 v[220:223], v[208:211], v[200:203], v[220:223]
    v_mfma_f32_16x16x32_bf16 v[224:227], v[208:211], v[204:207], v[224:227]
L_cs_88:
    s_cmp_lg_u32 s64, 2
    s_cbranch_scc1 L_warm_89
    v_lshrrev_b32 v234, 4, v1
    v_mul_u32_u24 v234, 3584, v234
    v_and_b32 v235, 15, v1
    v_min_u32 v235, 13, v235
    v_lshl_add_u32 v234, v235, 7, v234
    s_mul_i32 s81, s2, 14336
    s_add_u32 s81, s81, 1792
    s_sub_u32 s82, s81, 1604608
    s_cmp_lt_u32 s2, 112
    s_cselect_b32 s81, s81, s82
    s_cselect_b32 s60, s28, s32
    s_cselect_b32 s61, s29, s33
    s_cselect_b32 s62, s30, s34
    s_mov_b32 s63, 0x20000
    buffer_load_dword v0, v234, s[60:63], s81 offen
L_warm_89:
    s_waitcnt lgkmcnt(6)
    v_mfma_f32_32x32x16_bf16 v[48:63], v[176:179], v[128:131], v[48:63]
    ds_read_b128 v[132:135], v9
    ds_read_b64_tr_b16 v[192:193], v14 offset:8192
    ds_read_b64_tr_b16 v[194:195], v14 offset:8704
    v_subrev_u32 v232, 0x18000, v232
    ds_read_b128 v[240:243], v232
    ds_read_b128 v[244:247], v232 offset:1024
    s_waitcnt lgkmcnt(9)
    v_mfma_f32_32x32x16_bf16 v[64:79], v[180:183], v[128:131], v[64:79]
    ds_read_b64_tr_b16 v[196:197], v14 offset:9216
    ds_read_b64_tr_b16 v[198:199], v14 offset:9728
    s_lshl_b32 s81, s64, 12
    s_add_u32 m0, s81, 0x1c000
    s_add_u32 s72, s72, 0x2aa80
    buffer_load_dwordx4 v6, s[36:39], s72 offen lds
    s_waitcnt lgkmcnt(2)
    v_dot2c_f32_bf16 v228, s11, v240
    v_dot2c_f32_bf16 v229, v240, v240
    v_dot2c_f32_bf16 v230, s11, v244
    v_dot2c_f32_bf16 v231, v244, v244
    v_dot2c_f32_bf16 v228, s11, v241
    v_dot2c_f32_bf16 v229, v241, v241
    v_dot2c_f32_bf16 v230, s11, v245
    v_dot2c_f32_bf16 v231, v245, v245
    v_dot2c_f32_bf16 v228, s11, v242
    v_dot2c_f32_bf16 v229, v242, v242
    v_dot2c_f32_bf16 v230, s11, v246
    v_dot2c_f32_bf16 v231, v246, v246
    v_dot2c_f32_bf16 v228, s11, v243
    v_dot2c_f32_bf16 v229, v243, v243
    v_dot2c_f32_bf16 v230, s11, v247
    v_dot2c_f32_bf16 v231, v247, v247
    v_mfma_f32_32x32x16_bf16 v[80:95], v[184:187], v[128:131], v[80:95]
    ds_read_b64_tr_b16 v[200:201], v14 offset:10240
    ds_read_b64_tr_b16 v[202:203], v14 offset:10752
    v_mfma_f32_32x32x16_bf16 v[96:111], v[188:191], v[128:131], v[96:111]
    ds_read_b64_tr_b16 v[204:205], v14 offset:11264
    ds_read_b64_tr_b16 v[206:207], v14 offset:11776
    s_sub_u32 s72, s72, 896
    buffer_load_dwordx4 v6, s[36:39], s72 offen offset:1024 lds
    s_cmp_lg_u32 s88, 0
    s_cbranch_scc1 L_cs_90
    v_mfma_f32_16x16x32_bf16 v[212:215], v[208:211], v[176:179], v[212:215]
    v_mfma_f32_16x16x32_bf16 v[216:219], v[208:211], v[180:183], v[216:219]
    v_mfma_f32_16x16x32_bf16 v[220:223], v[208:211], v[184:187], v[220:223]
    v_mfma_f32_16x16x32_bf16 v[224:227], v[208:211], v[188:191], v[224:227]
L_cs_90:
    v_mfma_f32_32x32x16_bf16 v[48:63], v[192:195], v[132:135], v[48:63]
    ds_read_b128 v[136:139], v10
    ds_read_b64_tr_b16 v[176:177], v14 offset:16384
    ds_read_b64_tr_b16 v[178:179], v14 offset:16896
    s_waitcnt lgkmcnt(7)
    v_mfma_f32_32x32x16_bf16 v[64:79], v[196:199], v[132:135], v[64:79]
    ds_read_b64_tr_b16 v[180:181], v14 offset:17408
    ds_read_b64_tr_b16 v[182:183], v14 offset:17920
    s_sub_u32 s72, s72, 896
    buffer_load_dwordx4 v6, s[36:39], s72 offen offset:2048 lds
    s_waitcnt lgkmcnt(7)
    v_mfma_f32_32x32x16_bf16 v[80:95], v[200:203], v[132:135], v[80:95]
    ds_read_b64_tr_b16 v[184:185], v14 offset:18432
    ds_read_b64_tr_b16 v[186:187], v14 offset:18944
    s_waitcnt lgkmcnt(7)
    v_mfma_f32_32x32x16_bf16 v[96:111], v[204:207], v[132:135], v[96:111]
    ds_read_b64_tr_b16 v[188:189], v14 offset:19456
    ds_read_b64_tr_b16 v[190:191], v14 offset:19968
    s_sub_u32 s72, s72, 896
    buffer_load_dwordx4 v6, s[36:39], s72 offen offset:3072 lds
    s_cmp_lg_u32 s88, 1
    s_cbranch_scc1 L_cs_91
    v_mfma_f32_16x16x32_bf16 v[212:215], v[208:211], v[192:195], v[212:215]
    v_mfma_f32_16x16x32_bf16 v[216:219], v[208:211], v[196:199], v[216:219]
    v_mfma_f32_16x16x32_bf16 v[220:223], v[208:211], v[200:203], v[220:223]
    v_mfma_f32_16x16x32_bf16 v[224:227], v[208:211], v[204:207], v[224:227]
L_cs_91:
    s_waitcnt lgkmcnt(6)
    v_mfma_f32_32x32x16_bf16 v[48:63], v[176:179], v[136:139], v[48:63]
    ds_read_b128 v[140:143], v11
    ds_read_b64_tr_b16 v[192:193], v14 offset:24576
    ds_read_b64_tr_b16 v[194:195], v14 offset:25088
    s_waitcnt lgkmcnt(7)
    v_mfma_f32_32x32x16_bf16 v[64:79], v[180:183], v[136:139], v[64:79]
    ds_read_b64_tr_b16 v[196:197], v14 offset:25600
    ds_read_b64_tr_b16 v[198:199], v14 offset:26112
    s_waitcnt lgkmcnt(7)
    v_mfma_f32_32x32x16_bf16 v[80:95], v[184:187], v[136:139], v[80:95]
    ds_read_b64_tr_b16 v[200:201], v14 offset:26624
    ds_read_b64_tr_b16 v[202:203], v14 offset:27136
    s_waitcnt lgkmcnt(7)
    v_mfma_f32_32x32x16_bf16 v[96:111], v[188:191], v[136:139], v[96:111]
    ds_read_b64_tr_b16 v[204:205], v14 offset:27648
    ds_read_b64_tr_b16 v[206:207], v14 offset:28160
    s_cmp_lg_u32 s88, 2
    s_cbranch_scc1 L_cs_92
    v_mfma_f32_16x16x32_bf16 v[212:215], v[208:211], v[176:179], v[212:215]
    v_mfma_f32_16x16x32_bf16 v[216:219], v[208:211], v[180:183], v[216:219]
    v_mfma_f32_16x16x32_bf16 v[220:223], v[208:211], v[184:187], v[220:223]
    v_mfma_f32_16x16x32_bf16 v[224:227], v[208:211], v[188:191], v[224:227]
L_cs_92:
    s_waitcnt lgkmcnt(6)
    v_mfma_f32_32x32x16_bf16 v[48:63], v[192:195], v[140:143], v[48:63]
    s_waitcnt vmcnt(6) lgkmcnt(0)
    s_barrier
    v_add_u32 v8, 0xc000, v8
    v_add_u32 v9, 0xc000, v9
    v_add_u32 v10, 0xc000, v10
    v_add_u32 v11, 0xc000, v11
    ds_read_b128 v[128:131], v8
    v_add_u32 v14, 0xc000, v14
    ds_read_b64_tr_b16 v[176:177], v14
    ds_read_b64_tr_b16 v[178:179], v14 offset:512
    v_mfma_f32_32x32x16_bf16 v[64:79], v[196:199], v[140:143], v[64:79]
    ds_read_b64_tr_b16 v[180:181], v14 offset:1024
    ds_read_b64_tr_b16 v[182:183], v14 offset:1536
    s_add_u32 m0, s68, 0x0
    s_add_u32 s69, s69, 128
    buffer_load_dwordx4 v2, s[24:27], s69 offen lds
    v_mfma_f32_32x32x16_bf16 v[80:95], v[200:203], v[140:143], v[80:95]
    ds_read_b64_tr_b16 v[184:185], v14 offset:2048
    ds_read_b64_tr_b16 v[186:187], v14 offset:2560
    v_mfma_f32_32x32x16_bf16 v[96:111], v[204:207], v[140:143], v[96:111]
    ds_read_b64_tr_b16 v[188:189], v14 offset:3072
    ds_read_b64_tr_b16 v[190:191], v14 offset:3584
    buffer_load_dwordx4 v3, s[24:27], s69 offen offset:1024 lds
    s_cmp_lg_u32 s88, 3
    s_cbranch_scc1 L_cs_93
    v_mfma_f32_16x16x32_bf16 v[212:215], v[208:211], v[192:195], v[212:215]
    v_mfma_f32_16x16x32_bf16 v[216:219], v[208:211], v[196:199], v[216:219]
    v_mfma_f32_16x16x32_bf16 v[220:223], v[208:211], v[200:203], v[220:223]
    v_mfma_f32_16x16x32_bf16 v[224:227], v[208:211], v[204:207], v[224:227]
L_cs_93:
    s_waitcnt lgkmcnt(6)
    v_mfma_f32_32x32x16_bf16 v[48:63], v[176:179], v[128:131], v[48:63]
    ds_read_b128 v[132:135], v9
    ds_read_b64_tr_b16 v[192:193], v14 offset:8192
    ds_read_b64_tr_b16 v[194:195], v14 offset:8704
    v_add_u32 v232, 0xc000, v232
    ds_read_b128 v[240:243], v232
    ds_read_b128 v[244:247], v232 offset:1024
    s_waitcnt lgkmcnt(9)
    v_mfma_f32_32x32x16_bf16 v[64:79], v[180:183], v[128:131], v[64:79]
    ds_read_b64_tr_b16 v[196:197], v14 offset:9216
    ds_read_b64_tr_b16 v[198:199], v14 offset:9728
    s_lshl_b32 s81, s64, 12
    s_add_u32 m0, s81, 0x4000
    s_add_u32 s72, s72, 0x2aa80
    buffer_load_dwordx4 v6, s[36:39], s72 offen lds
    s_waitcnt lgkmcnt(2)
    v_dot2c_f32_bf16 v228, s11, v240
    v_dot2c_f32_bf16 v229, v240, v240
    v_dot2c_f32_bf16 v230, s11, v244
    v_dot2c_f32_bf16 v231, v244, v244
    v_dot2c_f32_bf16 v228, s11, v241
    v_dot2c_f32_bf16 v229, v241, v241
    v_dot2c_f32_bf16 v230, s11, v245
    v_dot2c_f32_bf16 v231, v245, v245
    v_dot2c_f32_bf16 v228, s11, v242
    v_dot2c_f32_bf16 v229, v242, v242
    v_dot2c_f32_bf16 v230, s11, v246
    v_dot2c_f32_bf16 v231, v246, v246
    v_dot2c_f32_bf16 v228, s11, v243
    v_dot2c_f32_bf16 v229, v243, v243
    v_dot2c_f32_bf16 v230, s11, v247
    v_dot2c_f32_bf16 v231, v247, v247
    v_mfma_f32_32x32x16_bf16 v[80:95], v[184:187], v[128:131], v[80:95]
    ds_read_b64_tr_b16 v[200:201], v14 offset:10240
    ds_read_b64_tr_b16 v[202:203], v14 offset:10752
    v_mfma_f32_32x32x16_bf16 v[96:111], v[188:191], v[128:131], v[96:111]
    ds_read_b64_tr_b16 v[204:205], v14 offset:11264
    ds_read_b64_tr_b16 v[206:207], v14 offset:11776
    s_sub_u32 s72, s72, 896
    buffer_load_dwordx4 v6, s[36:39], s72 offen offset:1024 lds
    s_cmp_lg_u32 s88, 0
    s_cbranch_scc1 L_cs_94
    v_mfma_f32_16x16x32_bf16 v[212:215], v[208:211], v[176:179], v[212:215]
    v_mfma_f32_16x16x32_bf16 v[216:219], v[208:211], v[180:183], v[216:219]
    v_mfma_f32_16x16x32_bf16 v[220:223], v[208:211], v[184:187], v[220:223]
    v_mfma_f32_16x16x32_bf16 v[224:227], v[208:211], v[188:191], v[224:227]
L_cs_94:
    v_mfma_f32_32x32x16_bf16 v[48:63], v[192:195], v[132:135], v[48:63]
    ds_read_b128 v[136:139], v10
    ds_read_b64_tr_b16 v[176:177], v14 offset:16384
    ds_read_b64_tr_b16 v[178:179], v14 offset:16896
    s_waitcnt lgkmcnt(7)
    v_mfma_f32_32x32x16_bf16 v[64:79], v[196:199], v[132:135], v[64:79]
    ds_read_b64_tr_b16 v[180:181], v14 offset:17408
    ds_read_b64_tr_b16 v[182:183], v14 offset:17920
    s_sub_u32 s72, s72, 896
    buffer_load_dwordx4 v6, s[36:39], s72 offen offset:2048 lds
    s_waitcnt lgkmcnt(7)
    v_mfma_f32_32x32x16_bf16 v[80:95], v[200:203], v[132:135], v[80:95]
    ds_read_b64_tr_b16 v[184:185], v14 offset:18432
    ds_read_b64_tr_b16 v[186:187], v14 offset:18944
    s_waitcnt lgkmcnt(7)
    v_mfma_f32_32x32x16_bf16 v[96:111], v[204:207], v[132:135], v[96:111]
    ds_read_b64_tr_b16 v[188:189], v14 offset:19456
    ds_read_b64_tr_b16 v[190:191], v14 offset:19968
    s_sub_u32 s72, s72, 896
    buffer_load_dwordx4 v6, s[36:39], s72 offen offset:3072 lds
    s_cmp_lg_u32 s88, 1
    s_cbranch_scc1 L_cs_95
    v_mfma_f32_16x16x32_bf16 v[212:215], v[208:211], v[192:195], v[212:215]
    v_mfma_f32_16x16x32_bf16 v[216:219], v[208:211], v[196:199], v[216:219]
    v_mfma_f32_16x16x32_bf16 v[220:223], v[208:211], v[200:203], v[220:223]
    v_mfma_f32_16x16x32_bf16 v[224:227], v[208:211], v[204:207], v[224:227]
L_cs_95:
    s_waitcnt lgkmcnt(6)
    v_mfma_f32_32x32x16_bf16 v[48:63], v[176:179], v[136:139], v[48:63]
    ds_read_b128 v[140:143], v11
    ds_read_b64_tr_b16 v[192:193], v14 offset:24576
    ds_read_b64_tr_b16 v[194:195], v14 offset:25088
    s_waitcnt lgkmcnt(7)
    v_mfma_f32_32x32x16_bf16 v[64:79], v[180:183], v[136:139], v[64:79]
    ds_read_b64_tr_b16 v[196:197], v14 offset:25600
    ds_read_b64_tr_b16 v[198:199], v14 offset:26112
    s_waitcnt lgkmcnt(7)
    v_mfma_f32_32x32x16_bf16 v[80:95], v[184:187], v[136:139], v[80:95]
    ds_read_b64_tr_b16 v[200:201], v14 offset:26624
    ds_read_b64_tr_b16 v[202:203], v14 offset:27136
    s_waitcnt lgkmcnt(7)
    v_mfma_f32_32x32x16_bf16 v[96:111], v[188:191], v[136:139], v[96:111]
    ds_read_b64_tr_b16 v[204:205], v14 offset:27648
    ds_read_b64_tr_b16 v[206:207], v14 offset:28160
    s_cmp_lg_u32 s88, 2
    s_cbranch_scc1 L_cs_96
    v_mfma_f32_16x16x32_bf16 v[212:215], v[208:211], v[176:179], v[212:215]
    v_mfma_f32_16x16x32_bf16 v[216:219], v[208:211], v[180:183], v[216:219]
    v_mfma_f32_16x16x32_bf16 v[220:223], v[208:211], v[184:187], v[220:223]
    v_mfma_f32_16x16x32_bf16 v[224:227], v[208:211], v[188:191], v[224:227]
L_cs_96:
    s_waitcnt lgkmcnt(6)
    v_mfma_f32_32x32x16_bf16 v[48:63], v[192:195], v[140:143], v[48:63]
    s_waitcnt vmcnt(6) lgkmcnt(0)
    s_barrier
    s_cmp_lg_u32 s64, 0
    s_cbranch_scc1 L_w0_97
    v_mov_b32 v23, 0
    buffer_load_dword v22, v23, s[56:59], 0 offen sc1
L_w0_97:
    v_add_u32 v8, 0xc000, v8
    v_add_u32 v9, 0xc000, v9
    v_add_u32 v10, 0xc000, v10
    v_add_u32 v11, 0xc000, v11
    ds_read_b128 v[128:131], v8
    v_add_u32 v14, 0xc000, v14
    ds_read_b64_tr_b16 v[176:177], v14
    ds_read_b64_tr_b16 v[178:179], v14 offset:512
    v_mfma_f32_32x32x16_bf16 v[64:79], v[196:199], v[140:143], v[64:79]
    ds_read_b64_tr_b16 v[180:181], v14 offset:1024
    ds_read_b64_tr_b16 v[182:183], v14 offset:1536
    v_mfma_f32_32x32x16_bf16 v[80:95], v[200:203], v[140:143], v[80:95]
    ds_read_b64_tr_b16 v[184:185], v14 offset:2048
    ds_read_b64_tr_b16 v[186:187], v14 offset:2560
    v_mfma_f32_32x32x16_bf16 v[96:111], v[204:207], v[140:143], v[96:111]
    ds_read_b64_tr_b16 v[188:189], v14 offset:3072
    ds_read_b64_tr_b16 v[190:191], v14 offset:3584
    s_cmp_lg_u32 s88, 3
    s_cbranch_scc1 L_cs_98
    v_mfma_f32_16x16x32_bf16 v[212:215], v[208:211], v[192:195], v[212:215]
    v_mfma_f32_16x16x32_bf16 v[216:219], v[208:211], v[196:199], v[216:219]
    v_mfma_f32_16x16x32_bf16 v[220:223], v[208:211], v[200:203], v[220:223]
    v_mfma_f32_16x16x32_bf16 v[224:227], v[208:211], v[204:207], v[224:227]
L_cs_98:
    s_cmp_lg_u32 s64, 1
    s_cbranch_scc1 L_warm_99
    v_lshlrev_b32 v234, 7, v1
    s_lshl_b32 s81, s2, 13
    s_sub_u32 s82, s81, 1605632
    s_cmp_lt_u32 s2, 196
    s_cselect_b32 s81, s81, s82
    s_cselect_b32 s60, s16, s8
    s_cselect_b32 s61, s17, s9
    s_mov_b32 s62, 0x62000
    s_cselect_b32 s62, 0x188000, s62
    s_mov_b32 s63, 0x20000
    buffer_load_dword v0, v234, s[60:63], s81 offen
L_warm_99:
    s_waitcnt lgkmcnt(6)
    v_mfma_f32_32x32x16_bf16 v[48:63], v[176:179], v[128:131], v[48:63]
    ds_read_b128 v[132:135], v9
    ds_read_b64_tr_b16 v[192:193], v14 offset:8192
    ds_read_b64_tr_b16 v[194:195], v14 offset:8704
    v_add_u32 v232, 0xc000, v232
    ds_read_b128 v[240:243], v232
    ds_read_b128 v[244:247], v232 offset:1024
    s_waitcnt lgkmcnt(9)
    v_mfma_f32_32x32x16_bf16 v[64:79], v[180:183], v[128:131], v[64:79]
    ds_read_b64_tr_b16 v[196:197], v14 offset:9216
    ds_read_b64_tr_b16 v[198:199], v14 offset:9728
    s_waitcnt lgkmcnt(2)
    v_dot2c_f32_bf16 v228, s11, v240
    v_dot2c_f32_bf16 v229, v240, v240
    v_dot2c_f32_bf16 v230, s11, v244
    v_dot2c_f32_bf16 v231, v244, v244
    v_dot2c_f32_bf16 v228, s11, v241
    v_dot2c_f32_bf16 v229, v241, v241
    v_dot2c_f32_bf16 v230, s11, v245
    v_dot2c_f32_bf16 v231, v245, v245
    v_dot2c_f32_bf16 v228, s11, v242
    v_dot2c_f32_bf16 v229, v242, v242
    v_dot2c_f32_bf16 v230, s11, v246
    v_dot2c_f32_bf16 v231, v246, v246
    v_dot2c_f32_bf16 v228, s11, v243
    v_dot2c_f32_bf16 v229, v243, v243
    v_dot2c_f32_bf16 v230, s11, v247
    v_dot2c_f32_bf16 v231, v247, v247
    v_mfma_f32_32x32x16_bf16 v[80:95], v[184:187], v[128:131], v[80:95]
    ds_read_b64_tr_b16 v[200:201], v14 offset:10240
    ds_read_b64_tr_b16 v[202:203], v14 offset:10752
    v_mfma_f32_32x32x16_bf16 v[96:111], v[188:191], v[128:131], v[96:111]
    ds_read_b64_tr_b16 v[204:205], v14 offset:11264
    ds_read_b64_tr_b16 v[206:207], v14 offset:11776
    s_cmp_lg_u32 s88, 0
    s_cbranch_scc1 L_cs_100
    v_mfma_f32_16x16x32_bf16 v[212:215], v[208:211], v[176:179], v[212:215]
    v_mfma_f32_16x16x32_bf16 v[216:219], v[208:211], v[180:183], v[216:219]
    v_mfma_f32_16x16x32_bf16 v[220:223], v[208:211], v[184:187], v[220:223]
    v_mfma_f32_16x16x32_bf16 v[224:227], v[208:211], v[188:191], v[224:227]
L_cs_100:
    v_mfma_f32_32x32x16_bf16 v[48:63], v[192:195], v[132:135], v[48:63]
    ds_read_b128 v[136:139], v10
    ds_read_b64_tr_b16 v[176:177], v14 offset:16384
    ds_read_b64_tr_b16 v[178:179], v14 offset:16896
    s_waitcnt lgkmcnt(7)
    v_mfma_f32_32x32x16_bf16 v[64:79], v[196:199], v[132:135], v[64:79]
    ds_read_b64_tr_b16 v[180:181], v14 offset:17408
    ds_read_b64_tr_b16 v[182:183], v14 offset:17920
    s_waitcnt lgkmcnt(7)
    v_mfma_f32_32x32x16_bf16 v[80:95], v[200:203], v[132:135], v[80:95]
    ds_read_b64_tr_b16 v[184:185], v14 offset:18432
    ds_read_b64_tr_b16 v[186:187], v14 offset:18944
    s_waitcnt lgkmcnt(7)
    v_mfma_f32_32x32x16_bf16 v[96:111], v[204:207], v[132:135], v[96:111]
    ds_read_b64_tr_b16 v[188:189], v14 offset:19456
    ds_read_b64_tr_b16 v[190:191], v14 offset:19968
    s_cmp_lg_u32 s88, 1
    s_cbranch_scc1 L_cs_101
    v_mfma_f32_16x16x32_bf16 v[212:215], v[208:211], v[192:195], v[212:215]
    v_mfma_f32_16x16x32_bf16 v[216:219], v[208:211], v[196:199], v[216:219]
    v_mfma_f32_16x16x32_bf16 v[220:223], v[208:211], v[200:203], v[220:223]
    v_mfma_f32_16x16x32_bf16 v[224:227], v[208:211], v[204:207], v[224:227]
L_cs_101:
    s_waitcnt lgkmcnt(6)
    v_mfma_f32_32x32x16_bf16 v[48:63], v[176:179], v[136:139], v[48:63]
    ds_read_b128 v[140:143], v11
    ds_read_b64_tr_b16 v[192:193], v14 offset:24576
    ds_read_b64_tr_b16 v[194:195], v14 offset:25088
    s_waitcnt lgkmcnt(7)
    v_mfma_f32_32x32x16_bf16 v[64:79], v[180:183], v[136:139], v[64:79]
    ds_read_b64_tr_b16 v[196:197], v14 offset:25600
    ds_read_b64_tr_b16 v[198:199], v14 offset:26112
    s_waitcnt lgkmcnt(7)
    v_mfma_f32_32x32x16_bf16 v[80:95], v[184:187], v[136:139], v[80:95]
    ds_read_b64_tr_b16 v[200:201], v14 offset:26624
    ds_read_b64_tr_b16 v[202:203], v14 offset:27136
    s_waitcnt lgkmcnt(7)
    v_mfma_f32_32x32x16_bf16 v[96:111], v[188:191], v[136:139], v[96:111]
    ds_read_b64_tr_b16 v[204:205], v14 offset:27648
    ds_read_b64_tr_b16 v[206:207], v14 offset:28160
    s_cmp_lg_u32 s88, 2
    s_cbranch_scc1 L_cs_102
    v_mfma_f32_16x16x32_bf16 v[212:215], v[208:211], v[176:179], v[212:215]
    v_mfma_f32_16x16x32_bf16 v[216:219], v[208:211], v[180:183], v[216:219]
    v_mfma_f32_16x16x32_bf16 v[220:223], v[208:211], v[184:187], v[220:223]
    v_mfma_f32_16x16x32_bf16 v[224:227], v[208:211], v[188:191], v[224:227]
L_cs_102:
    s_waitcnt lgkmcnt(6)
    v_mfma_f32_32x32x16_bf16 v[48:63], v[192:195], v[140:143], v[48:63]
    s_cmp_lg_u32 s64, 0
    s_cbranch_scc1 L_w0_103
    s_mov_b32 s80, 100000
    s_waitcnt vmcnt(0)
L_pspin_104:
    v_cmp_le_u32 vcc, 1, v22
    s_nop 0
    s_cmp_eq_u64 vcc, -1
    s_nop 2
    s_cbranch_scc1 L_w0_103
    buffer_load_dword v22, v23, s[56:59], 0 offen sc1
    s_sub_u32 s80, s80, 1
    s_waitcnt vmcnt(0)
    s_cmp_lg_u32 s80, 0
    s_cbranch_scc1 L_pspin_104
L_w0_103:
    s_waitcnt vmcnt(0) lgkmcnt(0)
    s_barrier
    v_subrev_u32 v8, 0x18000, v8
    v_subrev_u32 v9, 0x18000, v9
    v_subrev_u32 v10, 0x18000, v10
    v_subrev_u32 v11, 0x18000, v11
    ds_read_b128 v[128:131], v8
    v_subrev_u32 v14, 0x18000, v14
    ds_read_b64_tr_b16 v[176:177], v14
    ds_read_b64_tr_b16 v[178:179], v14 offset:512
    v_mfma_f32_32x32x16_bf16 v[64:79], v[196:199], v[140:143], v[64:79]
    ds_read_b64_tr_b16 v[180:181], v14 offset:1024
    ds_read_b64_tr_b16 v[182:183], v14 offset:1536
    v_mfma_f32_32x32x16_bf16 v[80:95], v[200:203], v[140:143], v[80:95]
    ds_read_b64_tr_b16 v[184:185], v14 offset:2048
    ds_read_b64_tr_b16 v[186:187], v14 offset:2560
    v_mfma_f32_32x32x16_bf16 v[96:111], v[204:207], v[140:143], v[96:111]
    ds_read_b64_tr_b16 v[188:189], v14 offset:3072
    ds_read_b64_tr_b16 v[190:191], v14 offset:3584
    s_cmp_lg_u32 s88, 3
    s_cbranch_scc1 L_cs_105
    v_mfma_f32_16x16x32_bf16 v[212:215], v[208:211], v[192:195], v[212:215]
    v_mfma_f32_16x16x32_bf16 v[216:219], v[208:211], v[196:199], v[216:219]
    v_mfma_f32_16x16x32_bf16 v[220:223], v[208:211], v[200:203], v[220:223]
    v_mfma_f32_16x16x32_bf16 v[224:227], v[208:211], v[204:207], v[224:227]
L_cs_105:
    s_waitcnt lgkmcnt(6)
    v_mfma_f32_32x32x16_bf16 v[48:63], v[176:179], v[128:131], v[48:63]
    ds_read_b128 v[132:135], v9
    ds_read_b64_tr_b16 v[192:193], v14 offset:8192
    ds_read_b64_tr_b16 v[194:195], v14 offset:8704
    s_mul_i32 s81, s88, 8192
    v_add_u32 v160, s81, v14
    ds_read_b64_tr_b16 v[144:145], v160
    ds_read_b64_tr_b16 v[146:147], v160 offset:512
    ds_read_b64_tr_b16 v[148:149], v160 offset:1024
    ds_read_b64_tr_b16 v[150:151], v160 offset:1536
    ds_read_b64_tr_b16 v[152:153], v160 offset:2048
    ds_read_b64_tr_b16 v[154:155], v160 offset:2560
    ds_read_b64_tr_b16 v[156:157], v160 offset:3072
    ds_read_b64_tr_b16 v[158:159], v160 offset:3584
    s_waitcnt lgkmcnt(15)
    v_mfma_f32_32x32x16_bf16 v[64:79], v[180:183], v[128:131], v[64:79]
    ds_read_b64_tr_b16 v[196:197], v14 offset:9216
    ds_read_b64_tr_b16 v[198:199], v14 offset:9728
    s_waitcnt lgkmcnt(15)
    v_mfma_f32_32x32x16_bf16 v[80:95], v[184:187], v[128:131], v[80:95]
    ds_read_b64_tr_b16 v[200:201], v14 offset:10240
    ds_read_b64_tr_b16 v[202:203], v14 offset:10752
    s_waitcnt lgkmcnt(4)
    v_mfma_f32_16x16x32_bf16 v[212:215], v[208:211], v[144:147], v[212:215]
    v_mfma_f32_16x16x32_bf16 v[216:219], v[208:211], v[148:151], v[216:219]
    v_mfma_f32_16x16x32_bf16 v[220:223], v[208:211], v[152:155], v[220:223]
    v_mfma_f32_16x16x32_bf16 v[224:227], v[208:211], v[156:159], v[224:227]
    v_mfma_f32_32x32x16_bf16 v[96:111], v[188:191], v[128:131], v[96:111]
    ds_read_b64_tr_b16 v[204:205], v14 offset:11264
    ds_read_b64_tr_b16 v[206:207], v14 offset:11776
    v_subrev_u32 v232, 0x18000, v232
    ds_read_b128 v[240:243], v232
    ds_read_b128 v[244:247], v232 offset:1024
    v_mfma_f32_32x32x16_bf16 v[48:63], v[192:195], v[132:135], v[48:63]
    ds_read_b128 v[136:139], v10
    ds_read_b64_tr_b16 v[176:177], v14 offset:16384
    ds_read_b64_tr_b16 v[178:179], v14 offset:16896
    s_waitcnt lgkmcnt(3)
    v_dot2c_f32_bf16 v228, s11, v240
    v_dot2c_f32_bf16 v229, v240, v240
    v_dot2c_f32_bf16 v230, s11, v244
    v_dot2c_f32_bf16 v231, v244, v244
    v_dot2c_f32_bf16 v228, s11, v241
    v_dot2c_f32_bf16 v229, v241, v241
    v_dot2c_f32_bf16 v230, s11, v245
    v_dot2c_f32_bf16 v231, v245, v245
    v_dot2c_f32_bf16 v228, s11, v242
    v_dot2c_f32_bf16 v229, v242, v242
    v_dot2c_f32_bf16 v230, s11, v246
    v_dot2c_f32_bf16 v231, v246, v246
    v_dot2c_f32_bf16 v228, s11, v243
    v_dot2c_f32_bf16 v229, v243, v243
    v_dot2c_f32_bf16 v230, s11, v247
    v_dot2c_f32_bf16 v231, v247, v247
    v_mfma_f32_32x32x16_bf16 v[64:79], v[196:199], v[132:135], v[64:79]
    ds_read_b64_tr_b16 v[180:181], v14 offset:17408
    ds_read_b64_tr_b16 v[182:183], v14 offset:17920
    v_mfma_f32_32x32x16_bf16 v[80:95], v[200:203], v[132:135], v[80:95]
    ds_read_b64_tr_b16 v[184:185], v14 offset:18432
    ds_read_b64_tr_b16 v[186:187], v14 offset:18944
    v_add_f32 v228, v228, v228 quad_perm:[1,0,3,2]
    v_add_f32 v229, v229, v229 quad_perm:[1,0,3,2]
    v_add_f32 v230, v230, v230 quad_perm:[1,0,3,2]
    v_add_f32 v231, v231, v231 quad_perm:[1,0,3,2]
    v_add_f32 v228, v228, v228 quad_perm:[2,3,0,1]
    v_add_f32 v229, v229, v229 quad_perm:[2,3,0,1]
    v_add_f32 v230, v230, v230 quad_perm:[2,3,0,1]
    v_add_f32 v231, v231, v231 quad_perm:[2,3,0,1]
    v_mfma_f32_32x32x16_bf16 v[96:111], v[204:207], v[132:135], v[96:111]
    ds_read_b64_tr_b16 v[188:189], v14 offset:19456
    ds_read_b64_tr_b16 v[190:191], v14 offset:19968
    v_add_f32 v228, v228, v228 row_half_mirror
    v_add_f32 v229, v229, v229 row_half_mirror
    v_add_f32 v230, v230, v230 row_half_mirror
    v_add_f32 v231, v231, v231 row_half_mirror
    v_and_b32 v248, 0x38, v1
    s_lshl_b32 s81, s64, 7
    s_add_u32 s81, s81, 0x27800
    v_add_u32 v248, s81, v248
    ds_write_b64 v248, v[228:229]
    ds_write_b64 v248, v[230:231] offset:64
    s_waitcnt lgkmcnt(8)
    v_mfma_f32_32x32x16_bf16 v[48:63], v[176:179], v[136:139], v[48:63]
    ds_read_b128 v[140:143], v11
    ds_read_b64_tr_b16 v[192:193], v14 offset:24576
    ds_read_b64_tr_b16 v[194:195], v14 offset:25088
    v_cvt_pk_bf16_f32 v214, v212, v212
    v_cvt_pk_bf16_f32 v215, v213, v213
    v_cvt_pk_bf16_f32 v218, v216, v216
    v_cvt_pk_bf16_f32 v219, v217, v217
    v_cvt_pk_bf16_f32 v222, v220, v220
    v_cvt_pk_bf16_f32 v223, v221, v221
    v_cvt_pk_bf16_f32 v226, v224, v224
    v_cvt_pk_bf16_f32 v227, v225, v225
    s_waitcnt lgkmcnt(9)
    v_mfma_f32_32x32x16_bf16 v[64:79], v[180:183], v[136:139], v[64:79]
    ds_read_b64_tr_b16 v[196:197], v14 offset:25600
    ds_read_b64_tr_b16 v[198:199], v14 offset:26112
    v_lshlrev_b32 v214, 16, v214
    v_lshlrev_b32 v215, 16, v215
    v_lshlrev_b32 v218, 16, v218
    v_lshlrev_b32 v219, 16, v219
    v_lshlrev_b32 v222, 16, v222
    v_lshlrev_b32 v223, 16, v223
    v_lshlrev_b32 v226, 16, v226
    v_lshlrev_b32 v227, 16, v227
    s_waitcnt lgkmcnt(9)
    v_mfma_f32_32x32x16_bf16 v[80:95], v[184:187], v[136:139], v[80:95]
    ds_read_b64_tr_b16 v[200:201], v14 offset:26624
    ds_read_b64_tr_b16 v[202:203], v14 offset:27136
    v_sub_f32 v214, v212, v214
    v_sub_f32 v215, v213, v215
    v_sub_f32 v218, v216, v218
    v_sub_f32 v219, v217, v219
    v_sub_f32 v222, v220, v222
    v_sub_f32 v223, v221, v223
    v_sub_f32 v226, v224, v226
    v_sub_f32 v227, v225, v227
    s_waitcnt lgkmcnt(9)
    v_mfma_f32_32x32x16_bf16 v[96:111], v[188:191], v[136:139], v[96:111]
    ds_read_b64_tr_b16 v[204:205], v14 offset:27648
    ds_read_b64_tr_b16 v[206:207], v14 offset:28160
    v_cvt_pk_bf16_f32 v212, v212, v214
    v_cvt_pk_bf16_f32 v213, v213, v215
    v_cvt_pk_bf16_f32 v216, v216, v218
    v_cvt_pk_bf16_f32 v217, v217, v219
    v_cvt_pk_bf16_f32 v220, v220, v222
    v_cvt_pk_bf16_f32 v221, v221, v223
    v_cvt_pk_bf16_f32 v224, v224, v226
    v_cvt_pk_bf16_f32 v225, v225, v227
    s_waitcnt lgkmcnt(6)
    v_mfma_f32_32x32x16_bf16 v[48:63], v[192:195], v[140:143], v[48:63]
    v_and_b32 v234, 15, v1
    s_mul_i32 s81, s87, 2560
    s_lshl2_add_u32 s81, s88, s81
    s_add_u32 s81, s81, 0x26400
    v_lshl_add_u32 v234, v234, 4, s81
    s_mov_b64 exec, 0xffff
    ds_write_b32 v234, v212
    ds_write_b32 v234, v213 offset:256
    ds_write_b32 v234, v216 offset:512
    ds_write_b32 v234, v217 offset:768
    ds_write_b32 v234, v220 offset:1024
    ds_write_b32 v234, v221 offset:1280
    ds_write_b32 v234, v224 offset:1536
    ds_write_b32 v234, v225 offset:1792
    s_mov_b64 exec, -1
    s_waitcnt lgkmcnt(12)
    v_mfma_f32_32x32x16_bf16 v[64:79], v[196:199], v[140:143], v[64:79]
    s_waitcnt lgkmcnt(10)
    v_mfma_f32_32x32x16_bf16 v[80:95], v[200:203], v[140:143], v[80:95]
    s_waitcnt lgkmcnt(8)
    v_mfma_f32_32x32x16_bf16 v[96:111], v[204:207], v[140:143], v[96:111]
    s_waitcnt lgkmcnt(0)
    s_barrier
    v_and_b32 v234, 31, v1
    s_lshl_b32 s81, s88, 8
    s_add_u32 s81, s81, 0x27800
    v_lshl_add_u32 v234, v234, 3, s81
    ds_read_b64 v[18:19], v234
    s_waitcnt lgkmcnt(0)
    v_mul_f32 v18, 0xbb124925, v18
    v_mov_b32 v21, 0x3727c5ac
    v_cvt_pk_bf16_f32 v252, v18, v18
    v_fmac_f32 v21, 0x3b124925, v19
    v_lshlrev_b32 v253, 16, v252
    v_fma_f32 v20, -v18, v18, v21
    v_sub_f32 v253, v18, v253
    v_max_f32 v21, 0x3727c5ac, v20
    v_cvt_pk_bf16_f32 v253, v253, v253
    v_cmp_lt_u32 vcc, 31, v1
    v_rsq_f32 v19, v21
    s_nop 0
    v_cndmask_b32 v252, v252, v253, vcc
    v_mov_b32 v253, v252
    v_mov_b32 v254, v252
    v_mov_b32 v255, v252
    v_mul_f32 v20, 0xbfb8aa3b, v19
    ds_read_b128 v[248:251], v16
    s_waitcnt lgkmcnt(0)
    v_mfma_f32_32x32x16_bf16 v[48:63], v[248:251], v[252:255], v[48:63]
    ds_read_b128 v[248:251], v16 offset:512
    s_waitcnt lgkmcnt(0)
    v_mfma_f32_32x32x16_bf16 v[64:79], v[248:251], v[252:255], v[64:79]
    ds_read_b128 v[248:251], v16 offset:1024
    s_waitcnt lgkmcnt(0)
    v_mfma_f32_32x32x16_bf16 v[80:95], v[248:251], v[252:255], v[80:95]
    ds_read_b128 v[248:251], v16 offset:1536
    s_waitcnt lgkmcnt(0)
    v_mfma_f32_32x32x16_bf16 v[96:111], v[248:251], v[252:255], v[96:111]
    s_nop 2
    v_mul_f32 v48, v19, v48
    v_mul_f32 v49, v19, v49
    v_mul_f32 v50, v19, v50
    v_mul_f32 v51, v19, v51
    v_mul_f32 v52, v19, v52
    v_mul_f32 v53, v19, v53
    v_mul_f32 v54, v19, v54
    v_mul_f32 v55, v19, v55
    v_mul_f32 v56, v19, v56
    v_mul_f32 v57, v19, v57
    v_mul_f32 v58, v19, v58
    v_mul_f32 v59, v19, v59
    v_mul_f32 v60, v19, v60
    v_mul_f32 v61, v19, v61
    v_mul_f32 v62, v19, v62
    v_mul_f32 v63, v19, v63
    v_cvt_pk_bf16_f32 v48, v48, v49
    v_cvt_pk_bf16_f32 v49, v50, v51
    v_cvt_pk_bf16_f32 v50, v52, v53
    v_cvt_pk_bf16_f32 v51, v54, v55
    v_cvt_pk_bf16_f32 v52, v56, v57
    v_cvt_pk_bf16_f32 v53, v58, v59
    v_cvt_pk_bf16_f32 v54, v60, v61
    v_cvt_pk_bf16_f32 v55, v62, v63
    buffer_store_dwordx4 v[48:51], v15, s[52:55], s92 offen sc1
    buffer_store_dwordx4 v[52:55], v15, s[52:55], s92 offen offset:1024 sc1
    s_add_u32 s92, s92, 4096
    v_mul_f32 v64, v19, v64
    v_mul_f32 v65, v19, v65
    v_mul_f32 v66, v19, v66
    v_mul_f32 v67, v19, v67
    v_mul_f32 v68, v19, v68
    v_mul_f32 v69, v19, v69
    v_mul_f32 v70, v19, v70
    v_mul_f32 v71, v19, v71
    v_mul_f32 v72, v19, v72
    v_mul_f32 v73, v19, v73
    v_mul_f32 v74, v19, v74
    v_mul_f32 v75, v19, v75
    v_mul_f32 v76, v19, v76
    v_mul_f32 v77, v19, v77
    v_mul_f32 v78, v19, v78
    v_mul_f32 v79, v19, v79
    v_cvt_pk_bf16_f32 v64, v64, v65
    v_cvt_pk_bf16_f32 v65, v66, v67
    v_cvt_pk_bf16_f32 v66, v68, v69
    v_cvt_pk_bf16_f32 v67, v70, v71
    v_cvt_pk_bf16_f32 v68, v72, v73
    v_cvt_pk_bf16_f32 v69, v74, v75
    v_cvt_pk_bf16_f32 v70, v76, v77
    v_cvt_pk_bf16_f32 v71, v78, v79
    buffer_store_dwordx4 v[64:67], v15, s[52:55], s92 offen sc1
    buffer_store_dwordx4 v[68:71], v15, s[52:55], s92 offen offset:1024 sc1
    s_add_u32 s92, s92, 4096
    v_mul_f32 v80, v19, v80
    v_mul_f32 v81, v19, v81
    v_mul_f32 v82, v19, v82
    v_mul_f32 v83, v19, v83
    v_mul_f32 v84, v19, v84
    v_mul_f32 v85, v19, v85
    v_mul_f32 v86, v19, v86
    v_mul_f32 v87, v19, v87
    v_mul_f32 v88, v19, v88
    v_mul_f32 v89, v19, v89
    v_mul_f32 v90, v19, v90
    v_mul_f32 v91, v19, v91
    v_mul_f32 v92, v19, v92
    v_mul_f32 v93, v19, v93
    v_mul_f32 v94, v19, v94
    v_mul_f32 v95, v19, v95
    v_cvt_pk_bf16_f32 v80, v80, v81
    v_cvt_pk_bf16_f32 v81, v82, v83
    v_cvt_pk_bf16_f32 v82, v84, v85
    v_cvt_pk_bf16_f32 v83, v86, v87
    v_cvt_pk_bf16_f32 v84, v88, v89
    v_cvt_pk_bf16_f32 v85, v90, v91
    v_cvt_pk_bf16_f32 v86, v92, v93
    v_cvt_pk_bf16_f32 v87, v94, v95
    buffer_store_dwordx4 v[80:83], v15, s[52:55], s92 offen sc1
    buffer_store_dwordx4 v[84:87], v15, s[52:55], s92 offen offset:1024 sc1
    s_add_u32 s92, s92, 4096
    s_cmp_eq_u32 s66, 14
    s_cselect_b32 s92, s92, 0x40000000
    v_mul_f32 v96, v19, v96
    v_mul_f32 v97, v19, v97
    v_mul_f32 v98, v19, v98
    v_mul_f32 v99, v19, v99
    v_mul_f32 v100, v19, v100
    v_mul_f32 v101, v19, v101
    v_mul_f32 v102, v19, v102
    v_mul_f32 v103, v19, v103
    v_mul_f32 v104, v19, v104
    v_mul_f32 v105, v19, v105
    v_mul_f32 v106, v19, v106
    v_mul_f32 v107, v19, v107
    v_mul_f32 v108, v19, v108
    v_mul_f32 v109, v19, v109
    v_mul_f32 v110, v19, v110
    v_mul_f32 v111, v19, v111
    v_cvt_pk_bf16_f32 v96, v96, v97
    v_cvt_pk_bf16_f32 v97, v98, v99
    v_cvt_pk_bf16_f32 v98, v100, v101
    v_cvt_pk_bf16_f32 v99, v102, v103
    v_cvt_pk_bf16_f32 v100, v104, v105
    v_cvt_pk_bf16_f32 v101, v106, v107
    v_cvt_pk_bf16_f32 v102, v108, v109
    v_cvt_pk_bf16_f32 v103, v110, v111
    buffer_store_dwordx4 v[96:99], v15, s[52:55], s92 offen sc1
    buffer_store_dwordx4 v[100:103], v15, s[52:55], s92 offen offset:1024 sc1
    s_waitcnt vmcnt(0)
    s_barrier
    s_cmp_lg_u32 s64, 0
    s_cbranch_scc1 L_w0_106
    v_mov_b32 v234, 0x40000000
    s_lshl_b32 s81, s65, 8
    s_add_u32 s81, s81, 8192
    v_writelane_b32 v234, s81, 0
    v_mov_b32 v235, 1
    buffer_atomic_add v235, v234, s[52:55], 0 offen sc1
L_w0_106:
    s_sub_u32 s83, s65, 1
    s_max_i32 s83, s83, 0
    s_and_b32 s84, s66, 3
    s_cmp_eq_u32 s84, 0
    s_cselect_b32 s83, s83, s65
    s_lshl_b32 s12, s65, 8
    s_add_u32 s12, s12, 8192
    s_lshl_b32 s13, s83, 8
    s_add_u32 s13, s13, 8192
    s_cmp_lg_u32 s64, 0
    s_cbranch_scc1 L_w0_107
    v_mov_b32 v23, s12
    v_writelane_b32 v23, s13, 1
    buffer_load_dword v22, v23, s[52:55], 0 offen sc1
L_w0_107:
    s_lshr_b32 s7, s66, 2
    s_mul_i32 s7, s7, 7
    s_mul_i32 s8, s90, 84
    s_add_u32 s8, s8, s7
    s_lshl_b32 s8, s8, 10
    s_add_u32 s8, s8, 0x80000
    s_mul_i32 s94, s90, 28
    s_add_u32 s94, s94, s7
    s_add_u32 s94, s94, s64
    s_lshl_b32 s94, s94, 10
    s_add_u32 s94, s94, 0xcc0000
    s_cmp_lt_u32 s64, 7
    s_cselect_b32 s94, s94, 0x40000000
    v_lshrrev_b32 v6, 4, v1
    s_add_u32 s4, s8, s67
    s_add_u32 s5, s4, 28672
    s_add_u32 s6, s4, 57344
    v_lshlrev_b32 v6, 9, v6
    s_mul_i32 s9, s87, 28672
    s_add_u32 s9, s9, s8
    v_and_b32 v138, 15, v1
    s_lshl_b32 s7, s88, 11
    s_add_u32 s9, s9, s7
    v_lshl_add_u32 v6, v138, 4, v6
    s_add_u32 s9, s9, 0xffff2000
    s_cmp_eq_u32 s90, 0
    s_cselect_b32 s9, 0x40000000, s9
    v_add_u32 v6, 256, v6
    s_lshr_b32 s16, s64, 1
    s_mul_i32 s16, s16, 7
    s_and_b32 s17, s64, 1
    v_and_b32 v144, 15, v1
    v_lshrrev_b32 v145, 4, v1
    s_mov_b32 s96, 0xc000
    s_mov_b32 s97, 0x11400
    v_lshl_add_u32 v146, v145, 1, s16
    v_lshrrev_b32 v148, 2, v146
    v_lshlrev_b32 v148, 10, v148
    v_and_b32 v147, 1, v146
    v_lshl_or_b32 v148, v147, 9, v148
    v_bfe_u32 v147, v146, 1, 1
    v_lshl_or_b32 v148, v147, 3, v148
    v_add_u32 v146, 1, v146
    s_add_u32 s18, s16, 6
    v_min_u32 v146, s18, v146
    v_lshrrev_b32 v149, 2, v146
    v_lshlrev_b32 v149, 10, v149
    v_and_b32 v147, 1, v146
    v_lshl_or_b32 v149, v147, 9, v149
    v_bfe_u32 v147, v146, 1, 1
    v_lshl_or_b32 v149, v147, 3, v149
    v_lshl_add_u32 v146, v144, 1, s17
    v_lshlrev_b32 v146, 4, v146
    v_add3_u32 v150, v148, v146, s96
    v_add3_u32 v151, v149, v146, s96
    v_add_u32 v155, s16, v145
    v_lshrrev_b32 v160, 2, v155
    v_lshlrev_b32 v160, 10, v160
    v_and_b32 v147, 1, v155
    v_lshl_or_b32 v160, v147, 9, v160
    v_bfe_u32 v147, v155, 1, 1
    v_lshl_or_b32 v160, v147, 3, v160
    v_add_u32 v155, 4, v155
    v_lshrrev_b32 v161, 2, v155
    v_lshlrev_b32 v161, 10, v161
    v_and_b32 v147, 1, v155
    v_lshl_or_b32 v161, v147, 9, v161
    v_bfe_u32 v147, v155, 1, 1
    v_lshl_or_b32 v161, v147, 3, v161
    v_add3_u32 v160, v160, v146, s96
    v_add3_u32 v161, v161, v146, s96
    v_mov_b32 v147, 0x27c00
    v_cmp_gt_u32 s[60:61], 48, v1
    v_and_b32 v146, 255, v146
    s_nop 0
    v_cndmask_b32 v161, v147, v161, s[60:61]
    v_and_b32 v147, 8, v148
    v_lshrrev_b32 v152, 9, v148
    v_lshl_or_b32 v152, v152, 8, v147
    v_and_b32 v147, 8, v149
    v_lshrrev_b32 v153, 9, v149
    v_lshl_or_b32 v153, v153, 8, v147
    v_add3_u32 v152, v152, v146, s97
    v_add3_u32 v153, v153, v146, s97
    v_lshrrev_b32 v154, 2, v1
    v_lshl_add_u32 v154, v154, 1, s17
    v_lshlrev_b32 v154, 4, v154
    v_and_b32 v155, 3, v1
    v_add_u32 v155, s16, v155
    v_lshrrev_b32 v156, 2, v155
    v_lshlrev_b32 v156, 10, v156
    v_and_b32 v147, 1, v155
    v_lshl_or_b32 v156, v147, 9, v156
    v_bfe_u32 v147, v155, 1, 1
    v_lshl_or_b32 v156, v147, 3, v156
    v_add_u32 v155, 4, v155
    v_min_u32 v155, s18, v155
    v_lshrrev_b32 v157, 2, v155
    v_lshlrev_b32 v157, 10, v157
    v_and_b32 v147, 1, v155
    v_lshl_or_b32 v157, v147, 9, v157
    v_bfe_u32 v147, v155, 1, 1
    v_lshl_or_b32 v157, v147, 3, v157
    v_and_b32 v147, 8, v156
    v_lshrrev_b32 v158, 9, v156
    v_lshl_or_b32 v158, v158, 8, v147
    v_and_b32 v147, 8, v157
    v_lshrrev_b32 v159, 9, v157
    v_lshl_or_b32 v159, v159, 8, v147
    v_add3_u32 v156, v156, v154, s96
    v_add3_u32 v157, v157, v154, s96
    v_and_b32 v154, 255, v154
    v_add3_u32 v158, v158, v154, s97
    v_add3_u32 v159, v159, v154, s97
    v_lshlrev_b32 v146, 2, v145
    v_sub_u32 v146, v146, v144
    v_mov_b32 v147, 0xf149f2ca
    s_cmp_eq_u32 s90, 0
    s_cselect_b32 s19, 64, 9
    v_cmp_le_i32 s[60:61], s19, v146
    v_add_u32 v148, 7, v146
    v_cmp_ge_u32 s[62:63], 7, v148
    v_cndmask_b32 v168, v147, 0, s[60:61]
    s_sub_u32 s19, s19, 1
    v_cndmask_b32 v172, v147, 0, s[62:63]
    v_cmp_le_i32 s[60:61], s19, v146
    v_add_u32 v148, 8, v146
    v_cmp_ge_u32 s[62:63], 7, v148
    v_cndmask_b32 v169, v147, 0, s[60:61]
    s_sub_u32 s19, s19, 1
    v_cndmask_b32 v173, v147, 0, s[62:63]
    v_cmp_le_i32 s[60:61], s19, v146
    v_add_u32 v148, 9, v146
    v_cmp_ge_u32 s[62:63], 7, v148
    v_cndmask_b32 v170, v147, 0, s[60:61]
    s_sub_u32 s19, s19, 1
    v_cndmask_b32 v174, v147, 0, s[62:63]
    v_cmp_le_i32 s[60:61], s19, v146
    v_add_u32 v148, 10, v146
    v_cmp_ge_u32 s[62:63], 7, v148
    v_cndmask_b32 v171, v147, 0, s[60:61]
    s_nop 0
    v_cndmask_b32 v175, v147, 0, s[62:63]
    s_cmp_lg_u32 s64, 0
    s_cbranch_scc1 L_w0_108
    s_mov_b32 s80, 100000
    s_waitcnt vmcnt(0)
L_pspin_109:
    v_cmp_le_u32 vcc, 16, v22
    s_nop 0
    s_cmp_eq_u64 vcc, -1
    s_nop 2
    s_cbranch_scc1 L_w0_108
    buffer_load_dword v22, v23, s[52:55], 0 offen sc1
    s_sub_u32 s80, s80, 1
    s_waitcnt vmcnt(0)
    s_cmp_lg_u32 s80, 0
    s_cbranch_scc1 L_pspin_109
L_w0_108:
    s_barrier
    s_cmp_eq_u32 s64, 7
    s_cbranch_scc1 L_att7_110
    s_add_u32 m0, s67, 0xc000
    s_nop 0
    buffer_load_dwordx4 v15, s[52:55], s4 offen sc1 lds
    s_add_u32 m0, s67, 0xdc00
    s_nop 0
    buffer_load_dwordx4 v15, s[52:55], s5 offen sc1 lds
    s_add_u32 m0, s67, 0xf800
    s_nop 0
    buffer_load_dwordx4 v15, s[52:55], s6 offen sc1 lds
L_att7_110:
    s_add_u32 m0, s67, 0x11400
    s_nop 0
    buffer_load_dwordx4 v6, s[52:55], s9 offen sc1 lds
    s_waitcnt vmcnt(0)
    s_barrier
    ds_read_b64 v[164:165], v150
    ds_read_b64 v[166:167], v151
    ds_read_b64 v[180:181], v150 offset:7168
    ds_read_b64 v[182:183], v151 offset:7168
    ds_read_b64 v[176:177], v152
    ds_read_b64 v[178:179], v153
    ds_read_b64_tr_b16 v[184:185], v158 offset:4096
    ds_read_b64_tr_b16 v[186:187], v156 offset:14336
    ds_read_b64_tr_b16 v[188:189], v159 offset:4096
    ds_read_b64_tr_b16 v[190:191], v157 offset:14336
    v_cmp_gt_u32 vcc, 48, v1
    s_mov_b32 s84, 0x3e8b97f6
    s_waitcnt lgkmcnt(6)
    v_cndmask_b32 v166, 0, v166, vcc
    v_cndmask_b32 v167, 0, v167, vcc
    s_nop 1
    v_mfma_f32_16x16x32_bf16 v[172:175], v[180:183], v[164:167], v[172:175]
    s_waitcnt lgkmcnt(4)
    v_mfma_f32_16x16x32_bf16 v[168:171], v[176:179], v[164:167], v[168:171]
    s_nop 5
    v_max3_f32 v146, v172, v173, v174
    s_nop 0
    v_max3_f32 v146, v146, v175, v168
    v_max3_f32 v146, v146, v169, v170
    v_max_f32 v146, v146, v171
    v_mov_b32 v147, v146
    s_nop 1
    v_permlane16_swap_b32 v146, v147
    v_max_f32 v146, v146, v147
    v_mov_b32 v147, v146
    s_nop 1
    v_permlane32_swap_b32 v146, v147
    v_max_f32 v146, v146, v147
    v_mul_f32 v146, 0xbe8b97f6, v146
    v_fma_f32 v168, v168, s84, v146
    v_fma_f32 v169, v169, s84, v146
    v_fma_f32 v170, v170, s84, v146
    v_fma_f32 v171, v171, s84, v146
    v_fma_f32 v172, v172, s84, v146
    v_fma_f32 v173, v173, s84, v146
    v_fma_f32 v174, v174, s84, v146
    v_fma_f32 v175, v175, s84, v146
    v_exp_f32 v168, v168
    v_exp_f32 v169, v169
    v_exp_f32 v170, v170
    v_exp_f32 v171, v171
    v_exp_f32 v172, v172
    v_exp_f32 v173, v173
    v_exp_f32 v174, v174
    v_exp_f32 v175, v175
    v_cvt_pk_bf16_f32 v164, v168, v169
    v_cvt_pk_bf16_f32 v165, v170, v171
    v_cvt_pk_bf16_f32 v166, v172, v173
    v_cvt_pk_bf16_f32 v167, v174, v175
    s_waitcnt lgkmcnt(0)
    v_add_f32 v148, v168, v169
    v_mfma_f32_16x16x32_bf16 v[176:179], v[184:187], v[164:167], 0
    v_mfma_f32_16x16x32_bf16 v[180:183], v[188:191], v[164:167], 0
    v_add_f32 v148, v148, v170
    v_add_f32 v148, v148, v171
    v_add_f32 v148, v148, v172
    v_add_f32 v148, v148, v173
    v_add_f32 v148, v148, v174
    v_add_f32 v148, v148, v175
    v_mov_b32 v147, v148
    s_nop 1
    v_permlane16_swap_b32 v148, v147
    v_add_f32 v148, v148, v147
    v_mov_b32 v147, v148
    s_nop 1
    v_permlane32_swap_b32 v148, v147
    v_add_f32 v148, v148, v147
    v_rcp_f32 v148, v148
    s_nop 0
    v_mul_f32 v176, v176, v148
    v_mul_f32 v177, v177, v148
    v_mul_f32 v178, v178, v148
    v_mul_f32 v179, v179, v148
    v_mul_f32 v180, v180, v148
    v_mul_f32 v181, v181, v148
    v_mul_f32 v182, v182, v148
    v_mul_f32 v183, v183, v148
    v_cvt_pk_bf16_f32 v176, v176, v177
    v_cvt_pk_bf16_f32 v177, v178, v179
    v_cvt_pk_bf16_f32 v178, v180, v181
    v_cvt_pk_bf16_f32 v179, v182, v183
    ds_write_b64 v160, v[176:177]
    ds_write_b64 v161, v[178:179]
    s_waitcnt lgkmcnt(0)
    s_barrier
    s_add_u32 s81, s67, 0xc000
    v_add_u32 v234, s81, v15
    ds_read_b128 v[240:243], v234
    s_waitcnt lgkmcnt(0)
    buffer_store_dwordx4 v[240:243], v15, s[52:55], s94 offen sc1
    s_waitcnt vmcnt(0)
    s_barrier
    s_cmp_lg_u32 s64, 0
    s_cbranch_scc1 L_w0_111
    v_mov_b32 v234, 0x40000000
    s_lshl_b32 s81, s65, 8
    s_add_u32 s81, s81, 20480
    v_writelane_b32 v234, s81, 0
    v_mov_b32 v235, 1
    buffer_atomic_add v235, v234, s[52:55], 0 offen sc1
L_w0_111:
L_code_end:
    s_endpgm
.section .rodata,"a"
.p2align 6
.amdhsa_kernel recurrent_scan__sliding_local_dilated__swiglu_ffn__prompt_kernel
  .amdhsa_next_free_vgpr 256
  .amdhsa_next_free_sgpr 102
  .amdhsa_accum_offset 256
  .amdhsa_group_segment_fixed_size 0
  .amdhsa_kernarg_size 80
  .amdhsa_user_sgpr_count 2
  .amdhsa_user_sgpr_kernarg_segment_ptr 1
  .amdhsa_system_sgpr_workgroup_id_x 1
.end_amdhsa_kernel
```
